```python
import torch

def _softmax(x, axis=-1):
    return torch.softmax(x, dim=axis)
def _gelu(x):
    return torch.nn.functional.gelu(x, approximate="tanh")
def _silu(x):
    return torch.nn.functional.silu(x)
def _sigmoid(x):
    return torch.sigmoid(x)
def _layernorm(x, axis=-1, eps=1e-5):
    m = x.mean(dim=axis, keepdim=True)
    v = x.var(dim=axis, keepdim=True, unbiased=False)
    return (x - m) / torch.sqrt(v + eps)
def _scatter_add(tgt, idx, src, axis=0):
    return tgt.clone().index_add_(axis, idx, src)
def _segment_sum(src, seg, n):
    out = torch.zeros((n,) + src.shape[1:], dtype=src.dtype)
    return out.index_add_(0, seg, src)
def _pad(x, pw):
    flat = tuple(v for pair in reversed(pw) for v in pair)
    return torch.nn.functional.pad(x, flat)

kernel_name = 'standalone__gqa_softmax__near_ridge'

def setup_inputs():

    _w = (lambda a: (lambda t: t.to(torch.bfloat16) if t.is_floating_point() else t)(torch.as_tensor(a)))
    B, Hq, Hkv, Sq, Sk, D = 8, 32, 8, 320, 320, 128
    return {
        "q": _w((lambda *s: torch.randn(*s, dtype=torch.bfloat16) * 0.8)(B, Hq, Sq, D)),
        "k": _w((lambda *s: torch.randn(*s, dtype=torch.bfloat16) * 0.8)(B, Hkv, Sk, D)),
        "v": _w((lambda *s: torch.randn(*s, dtype=torch.bfloat16) * 0.05)(B, Hkv, Sk, D)),
    }

def reference(q, k, v):
    B, Hq, Sq, D = q.shape
    Hkv = k.shape[1]
    rep = Hq // Hkv
    k = (lambda x, n, axis: torch.repeat_interleave(x, n, dim=axis))(k, rep, axis=1)
    v = (lambda x, n, axis: torch.repeat_interleave(x, n, dim=axis))(v, rep, axis=1)
    scale = D ** -0.5
    scores = torch.einsum("bhqd,bhkd->bhqk", q, k) * scale
    p = _softmax(scores, axis=-1)
    return torch.einsum("bhqk,bhkd->bhqd", p, v)
```

```asm
; @launch grid=(256,1,1) block=(512,1,1) lds=163840
.amdgcn_target "amdgcn-amd-amdhsa--gfx950"
.text
.globl standalone__gqa_softmax__near_ridge_kernel
.p2align 8
.type standalone__gqa_softmax__near_ridge_kernel,@function
standalone__gqa_softmax__near_ridge_kernel:

    s_cmp_ge_u32 s2, 256
    s_cbranch_scc1 L_end
    s_load_dwordx4 s[4:7], s[0:1], 0
    s_load_dwordx4 s[8:11], s[0:1], 16
    s_load_dwordx2 s[46:47], s[0:1], 40
    v_lshrrev_b32 v1, 6, v0
    v_and_b32 v0, 63, v0
    s_nop 0
    v_readfirstlane_b32 s32, v1
    s_and_b32 s33, s2, 7
    s_lshr_b32 s34, s2, 3
    s_lshl_b32 s33, s33, 3
    s_lshr_b32 s35, s34, 2
    s_add_u32 s33, s33, s35
    s_and_b32 s34, s34, 3
    s_lshl_b32 s35, s33, 2
    s_add_u32 s35, s35, s34
    s_mul_i32 s30, s35, 81920
    s_mul_i32 s36, s33, 81920
    s_mov_b32 s28, 0x3e0293ee
    s_mov_b32 s29, 0xbe0293ee
    s_and_b32 s37, s32, 3
    s_mul_i32 s38, s37, 80
    s_lshr_b32 s31, s32, 2
    s_xor_b32 s31, s31, 1
    s_lshl_b32 s39, s31, 5
    s_sub_u32 s39, 32, s39
    s_add_u32 s39, s39, s38
    s_add_u32 s40, s38, 64

    v_and_b32 v33, 31, v0
    v_lshrrev_b32 v34, 5, v0
    v_and_b32 v35, 15, v0
    v_lshrrev_b32 v36, 4, v0
    v_lshrrev_b32 v37, 2, v0
    v_and_b32 v37, 3, v37
    v_and_b32 v38, 3, v0

    s_lshl_b32 s41, s37, 2
    v_add_u32 v39, s41, v36
    v_xor_b32 v39, v39, v35
    v_lshlrev_b32 v39, 4, v39
    v_lshl_or_b32 v40, v36, 8, v39
    s_and_b32 s41, s32, 1
    v_lshlrev_b32 v39, 1, v36
    v_or_b32 v39, s41, v39
    v_xor_b32 v39, v39, v35
    v_lshlrev_b32 v39, 4, v39
    v_lshl_or_b32 v1, v36, 8, v39
    s_waitcnt lgkmcnt(0)
    s_mov_b32 s12, s4
    s_and_b32 s13, s5, 0xffff
    s_mov_b32 s14, 20971520
    s_mov_b32 s15, 0x00020000
    s_mov_b32 s16, s6
    s_and_b32 s17, s7, 0xffff
    s_mov_b32 s18, 5242880
    s_mov_b32 s19, 0x00020000
    s_mov_b32 s20, s8
    s_and_b32 s21, s9, 0xffff
    s_mov_b32 s22, 5242880
    s_mov_b32 s23, 0x00020000
    s_mov_b32 s24, s10
    s_and_b32 s25, s11, 0xffff
    s_mov_b32 s26, 20971520
    s_mov_b32 s27, 0x00020000
    s_lshl_b32 s42, s32, 10
    s_add_u32 s43, s36, s42
    s_lshl_b32 s56, s37, 10
    s_add_u32 s57, s36, s56
    s_xor_b32 s58, s31, 1
    s_lshl_b32 s58, s58, 15
    s_add_u32 s58, s58, s56
    s_lshl_b32 s54, s39, 8
    s_add_u32 s54, s54, s30
    s_lshl_b32 s55, s40, 8
    s_add_u32 s55, s55, s30

    s_xor_b32 s58, s31, 1
    s_mul_i32 s58, s58, 49152
    s_add_u32 s58, s58, s56
    s_cmp_eq_u32 s31, 0
    s_cbranch_scc1 L_noq
    s_add_u32 s44, s58, 81920
    s_mov_b32 m0, s44
    s_add_u32 s45, s54, 0
    buffer_load_dwordx4 v40, s[12:15], s45 offen nt lds
    s_add_u32 s44, s58, 86016
    s_mov_b32 m0, s44
    s_add_u32 s45, s54, 1024
    buffer_load_dwordx4 v40, s[12:15], s45 offen nt lds
    s_add_u32 s44, s58, 90112
    s_mov_b32 m0, s44
    s_add_u32 s45, s54, 2048
    buffer_load_dwordx4 v40, s[12:15], s45 offen nt lds
    s_add_u32 s44, s58, 94208
    s_mov_b32 m0, s44
    s_add_u32 s45, s54, 3072
    buffer_load_dwordx4 v40, s[12:15], s45 offen nt lds
    s_add_u32 s44, s58, 98304
    s_mov_b32 m0, s44
    s_add_u32 s45, s54, 4096
    buffer_load_dwordx4 v40, s[12:15], s45 offen nt lds
    s_add_u32 s44, s58, 102400
    s_mov_b32 m0, s44
    s_add_u32 s45, s54, 5120
    buffer_load_dwordx4 v40, s[12:15], s45 offen nt lds
    s_add_u32 s44, s58, 106496
    s_mov_b32 m0, s44
    s_add_u32 s45, s54, 6144
    buffer_load_dwordx4 v40, s[12:15], s45 offen nt lds
    s_add_u32 s44, s58, 110592
    s_mov_b32 m0, s44
    s_add_u32 s45, s54, 7168
    buffer_load_dwordx4 v40, s[12:15], s45 offen nt lds

    s_branch L_q2
L_noq:
    s_add_u32 s44, s56, 0
    s_mov_b32 m0, s44
    s_add_u32 s45, s57, 0
    buffer_load_dwordx4 v40, s[16:19], s45 offen nt lds
    s_add_u32 s44, s56, 4096
    s_mov_b32 m0, s44
    s_add_u32 s45, s57, 4096
    buffer_load_dwordx4 v40, s[16:19], s45 offen nt lds
    s_add_u32 s44, s56, 8192
    s_mov_b32 m0, s44
    s_add_u32 s45, s57, 8192
    buffer_load_dwordx4 v40, s[16:19], s45 offen nt lds
    s_add_u32 s44, s56, 12288
    s_mov_b32 m0, s44
    s_add_u32 s45, s57, 12288
    buffer_load_dwordx4 v40, s[16:19], s45 offen nt lds
    s_add_u32 s44, s56, 16384
    s_mov_b32 m0, s44
    s_add_u32 s45, s57, 16384
    buffer_load_dwordx4 v40, s[16:19], s45 offen nt lds
    s_add_u32 s44, s56, 20480
    s_mov_b32 m0, s44
    s_add_u32 s45, s57, 20480
    buffer_load_dwordx4 v40, s[16:19], s45 offen nt lds
    s_add_u32 s44, s56, 24576
    s_mov_b32 m0, s44
    s_add_u32 s45, s57, 24576
    buffer_load_dwordx4 v40, s[16:19], s45 offen nt lds
    s_add_u32 s44, s56, 28672
    s_mov_b32 m0, s44
    s_add_u32 s45, s57, 28672
    buffer_load_dwordx4 v40, s[16:19], s45 offen nt lds
L_q2:

    v_xor_b32 v39, v34, v35
    v_lshlrev_b32 v39, 4, v39
    v_lshl_or_b32 v8, v33, 8, v39
    v_xor_b32 v9, 32, v8
    v_xor_b32 v10, 64, v8
    v_xor_b32 v11, 0x60, v8
    v_xor_b32 v12, 0x80, v8
    v_xor_b32 v13, 0xa0, v8
    v_xor_b32 v14, 0xc0, v8
    v_xor_b32 v15, 0xe0, v8
    v_lshl_add_u32 v39, v34, 2, v37
    v_lshlrev_b32 v39, 8, v39
    v_and_b32 v16, 1, v36
    v_lshlrev_b32 v16, 3, v16
    v_lshl_add_u32 v16, v37, 1, v16
    v_and_b32 v17, 1, v38
    v_xor_b32 v17, v17, v34
    v_add_u32 v16, v16, v17
    v_lshl_add_u32 v39, v16, 4, v39
    v_lshrrev_b32 v16, 1, v38
    v_lshl_add_u32 v39, v16, 3, v39
    v_add_u32 v16, 0x14000, v39
    v_xor_b32 v17, 32, v16
    v_xor_b32 v18, 64, v16
    v_xor_b32 v19, 0x60, v16
    v_add_u32 v39, s39, v35
    v_lshlrev_b32 v39, 8, v39
    v_and_b32 v20, 1, v36
    v_lshl_add_u32 v20, v20, 1, v34
    v_lshl_add_u32 v20, v20, 4, v39
    v_add_u32 v21, 0x1000, v20
    v_xor_b32 v39, v37, v36
    v_and_b32 v39, 1, v39
    v_or_b32 v39, v39, v38
    v_mov_b32 v42, 0x3f803f80
    v_cmp_eq_u32 vcc, 0, v39
    v_cndmask_b32 v26, 0, v42, vcc
    s_lshl_b32 s41, s37, 2
    s_add_u32 s44, s58, 0x14000
    v_add_u32 v42, s41, v38
    v_xor_b32 v41, v42, v34
    v_lshlrev_b32 v41, 4, v41
    v_lshl_add_u32 v41, v38, 8, v41
    v_lshrrev_b32 v39, 2, v33
    v_lshl_add_u32 v41, v39, 12, v41
    v_add_u32 v41, s44, v41
    v_add_u32 v39, s40, v35
    v_lshlrev_b32 v39, 8, v39
    v_lshl_add_u32 v2, v36, 4, v39

    s_cmp_eq_u32 s31, 1
    s_cbranch_scc1 L_B
    s_add_u32 s44, s56, 32768
    s_mov_b32 m0, s44
    s_add_u32 s45, s57, 32768
    buffer_load_dwordx4 v40, s[16:19], s45 offen nt lds
    s_add_u32 s44, s56, 36864
    s_mov_b32 m0, s44
    s_add_u32 s45, s57, 36864
    buffer_load_dwordx4 v40, s[16:19], s45 offen nt lds
    s_add_u32 s44, s56, 40960
    s_mov_b32 m0, s44
    s_add_u32 s45, s57, 40960
    buffer_load_dwordx4 v40, s[16:19], s45 offen nt lds
    s_add_u32 s44, s56, 45056
    s_mov_b32 m0, s44
    s_add_u32 s45, s57, 45056
    buffer_load_dwordx4 v40, s[16:19], s45 offen nt lds
    s_waitcnt vmcnt(8)
    s_barrier
    s_add_u32 s44, s56, 49152
    s_mov_b32 m0, s44
    s_add_u32 s45, s57, 49152
    buffer_load_dwordx4 v40, s[16:19], s45 offen nt lds
    s_add_u32 s44, s56, 53248
    s_mov_b32 m0, s44
    s_add_u32 s45, s57, 53248
    buffer_load_dwordx4 v40, s[16:19], s45 offen nt lds
    s_add_u32 s44, s56, 57344
    s_mov_b32 m0, s44
    s_add_u32 s45, s57, 57344
    buffer_load_dwordx4 v40, s[16:19], s45 offen nt lds
    s_add_u32 s44, s56, 61440
    s_mov_b32 m0, s44
    s_add_u32 s45, s57, 61440
    buffer_load_dwordx4 v40, s[16:19], s45 offen nt lds
    s_waitcnt vmcnt(8)
    s_barrier
    s_add_u32 s44, s56, 65536
    s_mov_b32 m0, s44
    s_add_u32 s45, s57, 65536
    buffer_load_dwordx4 v40, s[16:19], s45 offen nt lds
    s_add_u32 s44, s56, 69632
    s_mov_b32 m0, s44
    s_add_u32 s45, s57, 69632
    buffer_load_dwordx4 v40, s[16:19], s45 offen nt lds
    s_add_u32 s44, s56, 73728
    s_mov_b32 m0, s44
    s_add_u32 s45, s57, 73728
    buffer_load_dwordx4 v40, s[16:19], s45 offen nt lds
    s_add_u32 s44, s56, 77824
    s_mov_b32 m0, s44
    s_add_u32 s45, s57, 77824
    buffer_load_dwordx4 v40, s[16:19], s45 offen nt lds
    s_waitcnt vmcnt(8)
    s_barrier
    s_getpc_b64 s[60:61]
L_pc:
    s_sub_u32 s60, s60, L_pc-standalone__gqa_softmax__near_ridge_kernel
    s_subb_u32 s61, s61, 0
    v_mul_u32_u24 v43, 64, v0
    s_lshl_b32 s62, s37, 12
    v_add_u32 v43, s62, v43
    v_min_u32 v45, L_end-standalone__gqa_softmax__near_ridge_kernel, v43
    global_load_dword v44, v45, s[60:61]
    v_add_u32 v43, 16384, v43
    v_min_u32 v45, L_end-standalone__gqa_softmax__near_ridge_kernel, v43
    global_load_dword v44, v45, s[60:61]
    v_add_u32 v43, 16384, v43
    s_add_u32 s44, s58, 81920
    s_mov_b32 m0, s44
    s_add_u32 s45, s54, 0
    buffer_load_dwordx4 v40, s[12:15], s45 offen nt lds

    s_add_u32 s44, s58, 86016
    s_mov_b32 m0, s44
    s_add_u32 s45, s54, 1024
    buffer_load_dwordx4 v40, s[12:15], s45 offen nt lds

    s_add_u32 s44, s58, 90112
    s_mov_b32 m0, s44
    s_add_u32 s45, s54, 2048
    buffer_load_dwordx4 v40, s[12:15], s45 offen nt lds

    s_add_u32 s44, s58, 94208
    s_mov_b32 m0, s44
    s_add_u32 s45, s54, 3072
    buffer_load_dwordx4 v40, s[12:15], s45 offen nt lds

    s_add_u32 s44, s58, 98304
    s_mov_b32 m0, s44
    s_add_u32 s45, s54, 4096
    buffer_load_dwordx4 v40, s[12:15], s45 offen nt lds

    s_add_u32 s44, s58, 102400
    s_mov_b32 m0, s44
    s_add_u32 s45, s54, 5120
    buffer_load_dwordx4 v40, s[12:15], s45 offen nt lds

    s_add_u32 s44, s58, 106496
    s_mov_b32 m0, s44
    s_add_u32 s45, s54, 6144
    buffer_load_dwordx4 v40, s[12:15], s45 offen nt lds

    s_add_u32 s44, s58, 110592
    s_mov_b32 m0, s44
    s_add_u32 s45, s54, 7168
    buffer_load_dwordx4 v40, s[12:15], s45 offen nt lds
    s_waitcnt vmcnt(14)
    s_barrier
    s_add_u32 s44, s56, 81920
    s_mov_b32 m0, s44
    s_add_u32 s45, s57, 0
    buffer_load_dwordx4 v1, s[20:23], s45 offen nt lds
    s_add_u32 s44, s56, 86016
    s_mov_b32 m0, s44
    s_add_u32 s45, s57, 4096
    buffer_load_dwordx4 v1, s[20:23], s45 offen nt lds
    s_add_u32 s44, s56, 90112
    s_mov_b32 m0, s44
    s_add_u32 s45, s57, 8192
    buffer_load_dwordx4 v1, s[20:23], s45 offen nt lds
    s_add_u32 s44, s56, 94208
    s_mov_b32 m0, s44
    s_add_u32 s45, s57, 12288
    buffer_load_dwordx4 v1, s[20:23], s45 offen nt lds
    s_add_u32 s44, s56, 98304
    s_mov_b32 m0, s44
    s_add_u32 s45, s57, 16384
    buffer_load_dwordx4 v1, s[20:23], s45 offen nt lds
    s_add_u32 s44, s56, 102400
    s_mov_b32 m0, s44
    s_add_u32 s45, s57, 20480
    buffer_load_dwordx4 v1, s[20:23], s45 offen nt lds
    s_waitcnt vmcnt(16)
    s_barrier
    s_add_u32 s44, s56, 106496
    s_mov_b32 m0, s44
    s_add_u32 s45, s57, 24576
    buffer_load_dwordx4 v1, s[20:23], s45 offen nt lds
    s_add_u32 s44, s56, 110592
    s_mov_b32 m0, s44
    s_add_u32 s45, s57, 28672
    buffer_load_dwordx4 v1, s[20:23], s45 offen nt lds
    s_add_u32 s44, s56, 114688
    s_mov_b32 m0, s44
    s_add_u32 s45, s57, 32768
    buffer_load_dwordx4 v1, s[20:23], s45 offen nt lds
    s_add_u32 s44, s56, 118784
    s_mov_b32 m0, s44
    s_add_u32 s45, s57, 36864
    buffer_load_dwordx4 v1, s[20:23], s45 offen nt lds
    s_add_u32 s44, s56, 122880
    s_mov_b32 m0, s44
    s_add_u32 s45, s57, 40960
    buffer_load_dwordx4 v1, s[20:23], s45 offen nt lds
    s_add_u32 s44, s56, 126976
    s_mov_b32 m0, s44
    s_add_u32 s45, s57, 45056
    buffer_load_dwordx4 v1, s[20:23], s45 offen nt lds
    s_setprio 2
    v_xor_b32 v56, 0x0, v41
    v_xor_b32 v60, 0x20, v41
    v_xor_b32 v64, 0x40, v41
    v_xor_b32 v68, 0x60, v41
    v_xor_b32 v72, 0x80, v41
    v_xor_b32 v76, 0xa0, v41
    v_xor_b32 v80, 0xc0, v41
    v_xor_b32 v84, 0xe0, v41
    s_waitcnt vmcnt(12)
    ds_read_b128 v[56:59], v56
    ds_read_b128 v[60:63], v60
    ds_read_b128 v[64:67], v64
    ds_read_b128 v[68:71], v68
    ds_read_b128 v[72:75], v72
    ds_read_b128 v[76:79], v76
    ds_read_b128 v[80:83], v80
    ds_read_b128 v[84:87], v84
    s_setprio 2
    ds_read_b128 v[32:35], v8 offset:0
    ds_read_b128 v[36:39], v9 offset:0
    ds_read_b128 v[40:43], v10 offset:0
    ds_read_b128 v[44:47], v11 offset:0
    ds_read_b128 v[48:51], v12 offset:0
    s_waitcnt lgkmcnt(3)
    v_mfma_f32_32x32x16_bf16 v[88:103], v[32:35], v[56:59], 0
    s_add_u32 s44, s56, 131072
    s_mov_b32 m0, s44
    s_add_u32 s45, s57, 49152
    buffer_load_dwordx4 v1, s[20:23], s45 offen nt lds
    ds_read_b128 v[52:55], v13 offset:0
    v_mfma_f32_32x32x16_bf16 v[88:103], v[36:39], v[60:63], v[88:103]
    ds_read_b128 v[32:35], v14 offset:0
    s_waitcnt lgkmcnt(3)
    v_mfma_f32_32x32x16_bf16 v[88:103], v[40:43], v[64:67], v[88:103]
    s_add_u32 s44, s56, 135168
    s_mov_b32 m0, s44
    s_add_u32 s45, s57, 53248
    buffer_load_dwordx4 v1, s[20:23], s45 offen nt lds
    ds_read_b128 v[36:39], v15 offset:0
    v_mfma_f32_32x32x16_bf16 v[88:103], v[44:47], v[68:71], v[88:103]
    ds_read_b128 v[40:43], v8 offset:8192
    s_waitcnt lgkmcnt(3)
    v_mfma_f32_32x32x16_bf16 v[88:103], v[48:51], v[72:75], v[88:103]
    s_add_u32 s44, s56, 139264
    s_mov_b32 m0, s44
    s_add_u32 s45, s57, 57344
    buffer_load_dwordx4 v1, s[20:23], s45 offen nt lds
    ds_read_b128 v[44:47], v9 offset:8192
    v_mfma_f32_32x32x16_bf16 v[88:103], v[52:55], v[76:79], v[88:103]
    ds_read_b128 v[48:51], v10 offset:8192
    s_waitcnt lgkmcnt(3)
    v_mfma_f32_32x32x16_bf16 v[88:103], v[32:35], v[80:83], v[88:103]
    s_add_u32 s44, s56, 143360
    s_mov_b32 m0, s44
    s_add_u32 s45, s57, 61440
    buffer_load_dwordx4 v1, s[20:23], s45 offen nt lds
    ds_read_b128 v[52:55], v11 offset:8192
    v_mfma_f32_32x32x16_bf16 v[88:103], v[36:39], v[84:87], v[88:103]
    ds_read_b128 v[32:35], v12 offset:8192
    s_waitcnt lgkmcnt(3)
    v_mfma_f32_32x32x16_bf16 v[104:119], v[40:43], v[56:59], 0
    s_add_u32 s44, s56, 147456
    s_mov_b32 m0, s44
    s_add_u32 s45, s57, 65536
    buffer_load_dwordx4 v1, s[20:23], s45 offen nt lds
    ds_read_b128 v[36:39], v13 offset:8192
    v_mfma_f32_32x32x16_bf16 v[104:119], v[44:47], v[60:63], v[104:119]
    ds_read_b128 v[40:43], v14 offset:8192
    s_waitcnt lgkmcnt(3)
    v_mfma_f32_32x32x16_bf16 v[104:119], v[48:51], v[64:67], v[104:119]
    s_add_u32 s44, s56, 151552
    s_mov_b32 m0, s44
    s_add_u32 s45, s57, 69632
    buffer_load_dwordx4 v1, s[20:23], s45 offen nt lds
    ds_read_b128 v[44:47], v15 offset:8192
    v_mfma_f32_32x32x16_bf16 v[104:119], v[52:55], v[68:71], v[104:119]
    ds_read_b128 v[48:51], v8 offset:16384
    s_waitcnt lgkmcnt(3)
    v_mfma_f32_32x32x16_bf16 v[104:119], v[32:35], v[72:75], v[104:119]
    s_add_u32 s44, s56, 155648
    s_mov_b32 m0, s44
    s_add_u32 s45, s57, 73728
    buffer_load_dwordx4 v1, s[20:23], s45 offen nt lds
    ds_read_b128 v[52:55], v9 offset:16384
    v_mfma_f32_32x32x16_bf16 v[104:119], v[36:39], v[76:79], v[104:119]
    v_max_f32 v22, v88, v89
    v_max3_f32 v22, v22, v90, v91
    v_max3_f32 v22, v22, v92, v93
    v_max3_f32 v22, v22, v94, v95
    v_max3_f32 v22, v22, v96, v97
    v_max3_f32 v22, v22, v98, v99
    v_max3_f32 v22, v22, v100, v101
    v_max3_f32 v22, v22, v102, v103
    ds_read_b128 v[32:35], v10 offset:16384
    s_waitcnt lgkmcnt(3)
    v_mfma_f32_32x32x16_bf16 v[104:119], v[40:43], v[80:83], v[104:119]
    s_add_u32 s44, s56, 159744
    s_mov_b32 m0, s44
    s_add_u32 s45, s57, 77824
    buffer_load_dwordx4 v1, s[20:23], s45 offen nt lds
    ds_read_b128 v[36:39], v11 offset:16384
    v_mfma_f32_32x32x16_bf16 v[104:119], v[44:47], v[84:87], v[104:119]
    ds_read_b128 v[40:43], v12 offset:16384
    s_waitcnt lgkmcnt(3)
    v_mfma_f32_32x32x16_bf16 v[120:135], v[48:51], v[56:59], 0
    ds_read_b128 v[44:47], v13 offset:16384
    v_mfma_f32_32x32x16_bf16 v[120:135], v[52:55], v[60:63], v[120:135]
    ds_read_b128 v[48:51], v14 offset:16384
    s_waitcnt lgkmcnt(3)
    v_mfma_f32_32x32x16_bf16 v[120:135], v[32:35], v[64:67], v[120:135]
    ds_read_b128 v[52:55], v15 offset:16384
    v_mfma_f32_32x32x16_bf16 v[120:135], v[36:39], v[68:71], v[120:135]
    ds_read_b128 v[32:35], v8 offset:24576
    s_waitcnt lgkmcnt(3)
    v_mfma_f32_32x32x16_bf16 v[120:135], v[40:43], v[72:75], v[120:135]
    ds_read_b128 v[36:39], v9 offset:24576
    v_mfma_f32_32x32x16_bf16 v[120:135], v[44:47], v[76:79], v[120:135]
    ds_read_b128 v[40:43], v10 offset:24576
    s_waitcnt lgkmcnt(3)
    v_mfma_f32_32x32x16_bf16 v[120:135], v[48:51], v[80:83], v[120:135]
    v_max3_f32 v22, v22, v104, v105
    v_max3_f32 v22, v22, v106, v107
    v_max3_f32 v22, v22, v108, v109
    v_max3_f32 v22, v22, v110, v111
    v_max3_f32 v22, v22, v112, v113
    v_max3_f32 v22, v22, v114, v115
    v_max3_f32 v22, v22, v116, v117
    v_max3_f32 v22, v22, v118, v119
    ds_read_b128 v[44:47], v11 offset:24576
    v_mfma_f32_32x32x16_bf16 v[120:135], v[52:55], v[84:87], v[120:135]
    ds_read_b128 v[48:51], v12 offset:24576
    s_waitcnt lgkmcnt(3)
    v_mfma_f32_32x32x16_bf16 v[136:151], v[32:35], v[56:59], 0
    ds_read_b128 v[52:55], v13 offset:24576
    v_mfma_f32_32x32x16_bf16 v[136:151], v[36:39], v[60:63], v[136:151]
    ds_read_b128 v[32:35], v14 offset:24576
    s_waitcnt lgkmcnt(3)
    v_mfma_f32_32x32x16_bf16 v[136:151], v[40:43], v[64:67], v[136:151]
    ds_read_b128 v[36:39], v15 offset:24576
    v_mfma_f32_32x32x16_bf16 v[136:151], v[44:47], v[68:71], v[136:151]
    ds_read_b128 v[40:43], v8 offset:32768
    s_waitcnt lgkmcnt(3)
    v_mfma_f32_32x32x16_bf16 v[136:151], v[48:51], v[72:75], v[136:151]
    ds_read_b128 v[44:47], v9 offset:32768
    v_mfma_f32_32x32x16_bf16 v[136:151], v[52:55], v[76:79], v[136:151]
    ds_read_b128 v[48:51], v10 offset:32768
    s_waitcnt lgkmcnt(3)
    v_mfma_f32_32x32x16_bf16 v[136:151], v[32:35], v[80:83], v[136:151]
    v_max3_f32 v22, v22, v120, v121
    v_max3_f32 v22, v22, v122, v123
    v_max3_f32 v22, v22, v124, v125
    v_max3_f32 v22, v22, v126, v127
    v_max3_f32 v22, v22, v128, v129
    v_max3_f32 v22, v22, v130, v131
    v_max3_f32 v22, v22, v132, v133
    v_max3_f32 v22, v22, v134, v135
    ds_read_b128 v[52:55], v11 offset:32768
    v_mfma_f32_32x32x16_bf16 v[136:151], v[36:39], v[84:87], v[136:151]
    ds_read_b128 v[32:35], v12 offset:32768
    s_waitcnt lgkmcnt(3)
    v_mfma_f32_32x32x16_bf16 v[152:167], v[40:43], v[56:59], 0
    ds_read_b128 v[36:39], v13 offset:32768
    v_mfma_f32_32x32x16_bf16 v[152:167], v[44:47], v[60:63], v[152:167]
    ds_read_b128 v[40:43], v14 offset:32768
    s_waitcnt lgkmcnt(3)
    v_mfma_f32_32x32x16_bf16 v[152:167], v[48:51], v[64:67], v[152:167]
    ds_read_b128 v[44:47], v15 offset:32768
    v_mfma_f32_32x32x16_bf16 v[152:167], v[52:55], v[68:71], v[152:167]
    v_add_u32 v8, 0xa000, v8
    v_add_u32 v9, 0xa000, v9
    v_add_u32 v10, 0xa000, v10
    v_add_u32 v11, 0xa000, v11
    v_add_u32 v12, 0xa000, v12
    v_add_u32 v13, 0xa000, v13
    v_add_u32 v14, 0xa000, v14
    v_add_u32 v15, 0xa000, v15
    ds_read_b128 v[48:51], v8 offset:0
    s_waitcnt lgkmcnt(3)
    v_mfma_f32_32x32x16_bf16 v[152:167], v[32:35], v[72:75], v[152:167]
    v_max3_f32 v22, v22, v136, v137
    v_max3_f32 v22, v22, v138, v139
    v_max3_f32 v22, v22, v140, v141
    v_max3_f32 v22, v22, v142, v143
    v_max3_f32 v22, v22, v144, v145
    v_max3_f32 v22, v22, v146, v147
    v_max3_f32 v22, v22, v148, v149
    v_max3_f32 v22, v22, v150, v151
    ds_read_b128 v[52:55], v9 offset:0
    v_mfma_f32_32x32x16_bf16 v[152:167], v[36:39], v[76:79], v[152:167]
    ds_read_b128 v[32:35], v10 offset:0
    s_waitcnt lgkmcnt(3)
    v_mfma_f32_32x32x16_bf16 v[152:167], v[40:43], v[80:83], v[152:167]
    ds_read_b128 v[36:39], v11 offset:0
    v_mfma_f32_32x32x16_bf16 v[152:167], v[44:47], v[84:87], v[152:167]
    ds_read_b128 v[40:43], v12 offset:0
    s_waitcnt lgkmcnt(3)
    v_mfma_f32_32x32x16_bf16 v[168:183], v[48:51], v[56:59], 0
    ds_read_b128 v[44:47], v13 offset:0
    v_mfma_f32_32x32x16_bf16 v[168:183], v[52:55], v[60:63], v[168:183]
    ds_read_b128 v[48:51], v14 offset:0
    s_waitcnt lgkmcnt(3)
    v_mfma_f32_32x32x16_bf16 v[168:183], v[32:35], v[64:67], v[168:183]
    ds_read_b128 v[52:55], v15 offset:0
    v_mfma_f32_32x32x16_bf16 v[168:183], v[36:39], v[68:71], v[168:183]
    ds_read_b128 v[32:35], v8 offset:8192
    s_waitcnt lgkmcnt(3)
    v_mfma_f32_32x32x16_bf16 v[168:183], v[40:43], v[72:75], v[168:183]
    ds_read_b128 v[36:39], v9 offset:8192
    v_mfma_f32_32x32x16_bf16 v[168:183], v[44:47], v[76:79], v[168:183]
    ds_read_b128 v[40:43], v10 offset:8192
    s_waitcnt lgkmcnt(3)
    v_mfma_f32_32x32x16_bf16 v[168:183], v[48:51], v[80:83], v[168:183]
    v_max3_f32 v22, v22, v152, v153
    v_max3_f32 v22, v22, v154, v155
    v_max3_f32 v22, v22, v156, v157
    v_max3_f32 v22, v22, v158, v159
    v_max3_f32 v22, v22, v160, v161
    v_max3_f32 v22, v22, v162, v163
    v_max3_f32 v22, v22, v164, v165
    v_max3_f32 v22, v22, v166, v167
    ds_read_b128 v[44:47], v11 offset:8192
    v_mfma_f32_32x32x16_bf16 v[168:183], v[52:55], v[84:87], v[168:183]
    ds_read_b128 v[48:51], v12 offset:8192
    s_waitcnt lgkmcnt(3)
    v_mfma_f32_32x32x16_bf16 v[184:199], v[32:35], v[56:59], 0
    ds_read_b128 v[52:55], v13 offset:8192
    v_mfma_f32_32x32x16_bf16 v[184:199], v[36:39], v[60:63], v[184:199]
    ds_read_b128 v[32:35], v14 offset:8192
    s_waitcnt lgkmcnt(3)
    v_mfma_f32_32x32x16_bf16 v[184:199], v[40:43], v[64:67], v[184:199]
    ds_read_b128 v[36:39], v15 offset:8192
    v_mfma_f32_32x32x16_bf16 v[184:199], v[44:47], v[68:71], v[184:199]
    ds_read_b128 v[40:43], v8 offset:16384
    s_waitcnt lgkmcnt(3)
    v_mfma_f32_32x32x16_bf16 v[184:199], v[48:51], v[72:75], v[184:199]
    ds_read_b128 v[44:47], v9 offset:16384
    v_mfma_f32_32x32x16_bf16 v[184:199], v[52:55], v[76:79], v[184:199]
    ds_read_b128 v[48:51], v10 offset:16384
    s_waitcnt lgkmcnt(3)
    v_mfma_f32_32x32x16_bf16 v[184:199], v[32:35], v[80:83], v[184:199]
    v_max3_f32 v23, v22, v168, v169
    v_max3_f32 v23, v23, v170, v171
    v_max3_f32 v23, v23, v172, v173
    v_max3_f32 v23, v23, v174, v175
    v_max3_f32 v23, v23, v176, v177
    v_max3_f32 v23, v23, v178, v179
    v_max3_f32 v23, v23, v180, v181
    v_max3_f32 v23, v23, v182, v183
    ds_read_b128 v[52:55], v11 offset:16384
    v_mfma_f32_32x32x16_bf16 v[184:199], v[36:39], v[84:87], v[184:199]
    ds_read_b128 v[32:35], v12 offset:16384
    s_waitcnt lgkmcnt(3)
    v_mfma_f32_32x32x16_bf16 v[200:215], v[40:43], v[56:59], 0
    ds_read_b128 v[36:39], v13 offset:16384
    v_mfma_f32_32x32x16_bf16 v[200:215], v[44:47], v[60:63], v[200:215]
    ds_read_b128 v[40:43], v14 offset:16384
    s_waitcnt lgkmcnt(3)
    v_mfma_f32_32x32x16_bf16 v[200:215], v[48:51], v[64:67], v[200:215]
    ds_read_b128 v[44:47], v15 offset:16384
    v_mfma_f32_32x32x16_bf16 v[200:215], v[52:55], v[68:71], v[200:215]
    ds_read_b128 v[48:51], v8 offset:24576
    s_waitcnt lgkmcnt(3)
    v_mfma_f32_32x32x16_bf16 v[200:215], v[32:35], v[72:75], v[200:215]
    ds_read_b128 v[52:55], v9 offset:24576
    v_mfma_f32_32x32x16_bf16 v[200:215], v[36:39], v[76:79], v[200:215]
    ds_read_b128 v[32:35], v10 offset:24576
    s_waitcnt lgkmcnt(3)
    v_mfma_f32_32x32x16_bf16 v[200:215], v[40:43], v[80:83], v[200:215]
    v_max3_f32 v23, v23, v184, v185
    v_max3_f32 v23, v23, v186, v187
    v_max3_f32 v23, v23, v188, v189
    v_max3_f32 v23, v23, v190, v191
    v_max3_f32 v23, v23, v192, v193
    v_max3_f32 v23, v23, v194, v195
    v_max3_f32 v23, v23, v196, v197
    v_max3_f32 v23, v23, v198, v199
    ds_read_b128 v[36:39], v11 offset:24576
    v_mfma_f32_32x32x16_bf16 v[200:215], v[44:47], v[84:87], v[200:215]
    ds_read_b128 v[40:43], v12 offset:24576
    s_waitcnt lgkmcnt(3)
    v_mfma_f32_32x32x16_bf16 v[216:231], v[48:51], v[56:59], 0
    ds_read_b128 v[44:47], v13 offset:24576
    v_mfma_f32_32x32x16_bf16 v[216:231], v[52:55], v[60:63], v[216:231]
    ds_read_b128 v[48:51], v14 offset:24576
    s_waitcnt lgkmcnt(3)
    v_mfma_f32_32x32x16_bf16 v[216:231], v[32:35], v[64:67], v[216:231]
    ds_read_b128 v[52:55], v15 offset:24576
    v_mfma_f32_32x32x16_bf16 v[216:231], v[36:39], v[68:71], v[216:231]
    ds_read_b128 v[32:35], v8 offset:32768
    s_waitcnt lgkmcnt(3)
    v_mfma_f32_32x32x16_bf16 v[216:231], v[40:43], v[72:75], v[216:231]
    ds_read_b128 v[36:39], v9 offset:32768
    v_mfma_f32_32x32x16_bf16 v[216:231], v[44:47], v[76:79], v[216:231]
    ds_read_b128 v[40:43], v10 offset:32768
    s_waitcnt lgkmcnt(3)
    v_mfma_f32_32x32x16_bf16 v[216:231], v[48:51], v[80:83], v[216:231]
    v_max3_f32 v23, v23, v200, v201
    v_max3_f32 v23, v23, v202, v203
    v_max3_f32 v23, v23, v204, v205
    v_max3_f32 v23, v23, v206, v207
    v_max3_f32 v23, v23, v208, v209
    v_max3_f32 v23, v23, v210, v211
    v_max3_f32 v23, v23, v212, v213
    v_max3_f32 v23, v23, v214, v215
    ds_read_b128 v[44:47], v11 offset:32768
    v_mfma_f32_32x32x16_bf16 v[216:231], v[52:55], v[84:87], v[216:231]
    ds_read_b128 v[48:51], v12 offset:32768
    s_waitcnt lgkmcnt(3)
    v_mfma_f32_32x32x16_bf16 v[232:247], v[32:35], v[56:59], 0
    ds_read_b128 v[52:55], v13 offset:32768
    v_mfma_f32_32x32x16_bf16 v[232:247], v[36:39], v[60:63], v[232:247]
    ds_read_b128 v[32:35], v14 offset:32768
    s_waitcnt lgkmcnt(3)
    v_mfma_f32_32x32x16_bf16 v[232:247], v[40:43], v[64:67], v[232:247]
    ds_read_b128 v[36:39], v15 offset:32768
    v_mfma_f32_32x32x16_bf16 v[232:247], v[44:47], v[68:71], v[232:247]
    s_waitcnt lgkmcnt(2)
    v_mfma_f32_32x32x16_bf16 v[232:247], v[48:51], v[72:75], v[232:247]
    v_mfma_f32_32x32x16_bf16 v[232:247], v[52:55], v[76:79], v[232:247]
    s_waitcnt lgkmcnt(0)
    v_mfma_f32_32x32x16_bf16 v[232:247], v[32:35], v[80:83], v[232:247]
    v_mfma_f32_32x32x16_bf16 v[232:247], v[36:39], v[84:87], v[232:247]
    v_max3_f32 v23, v23, v216, v217
    v_max3_f32 v23, v23, v218, v219
    v_max3_f32 v23, v23, v220, v221
    v_max3_f32 v23, v23, v222, v223
    v_max3_f32 v23, v23, v224, v225
    v_max3_f32 v23, v23, v226, v227
    v_max3_f32 v23, v23, v228, v229
    v_max3_f32 v23, v23, v230, v231
    s_nop 3
    v_max3_f32 v23, v23, v232, v233
    v_max3_f32 v23, v23, v234, v235
    v_max3_f32 v23, v23, v236, v237
    v_max3_f32 v23, v23, v238, v239
    v_max3_f32 v23, v23, v240, v241
    v_max3_f32 v23, v23, v242, v243
    v_max3_f32 v23, v23, v244, v245
    v_max3_f32 v23, v23, v246, v247
    v_mov_b32 v3, v23
    s_nop 1
    v_permlane32_swap_b32 v23, v3
    v_max_f32 v23, v23, v3
    v_mov_b32 v8, v26
    v_mov_b32 v9, v26
    v_mov_b32 v10, v26
    v_mov_b32 v11, v26
    s_setprio 0
    v_mul_f32 v24, s29, v23
    v_fmamk_f32 v88, v88, 0x3e0293ee, v24
    v_fmamk_f32 v89, v89, 0x3e0293ee, v24
    v_fmamk_f32 v90, v90, 0x3e0293ee, v24
    v_fmamk_f32 v91, v91, 0x3e0293ee, v24
    v_fmamk_f32 v92, v92, 0x3e0293ee, v24
    v_fmamk_f32 v93, v93, 0x3e0293ee, v24
    v_fmamk_f32 v94, v94, 0x3e0293ee, v24
    v_fmamk_f32 v95, v95, 0x3e0293ee, v24
    v_exp_f32 v88, v88
    v_exp_f32 v89, v89
    v_exp_f32 v90, v90
    v_exp_f32 v91, v91
    v_exp_f32 v92, v92
    v_exp_f32 v93, v93
    v_exp_f32 v94, v94
    v_exp_f32 v95, v95
    v_cvt_pk_bf16_f32 v88, v88, v89
    v_cvt_pk_bf16_f32 v89, v90, v91
    v_cvt_pk_bf16_f32 v90, v92, v93
    v_cvt_pk_bf16_f32 v91, v94, v95
    s_waitcnt vmcnt(0)
    s_barrier
    v_fmamk_f32 v96, v96, 0x3e0293ee, v24
    v_fmamk_f32 v97, v97, 0x3e0293ee, v24
    v_fmamk_f32 v98, v98, 0x3e0293ee, v24
    v_fmamk_f32 v99, v99, 0x3e0293ee, v24
    v_fmamk_f32 v100, v100, 0x3e0293ee, v24
    v_fmamk_f32 v101, v101, 0x3e0293ee, v24
    v_fmamk_f32 v102, v102, 0x3e0293ee, v24
    v_fmamk_f32 v103, v103, 0x3e0293ee, v24
    v_exp_f32 v96, v96
    v_exp_f32 v97, v97
    v_exp_f32 v98, v98
    v_exp_f32 v99, v99
    v_exp_f32 v100, v100
    v_exp_f32 v101, v101
    v_exp_f32 v102, v102
    v_exp_f32 v103, v103
    v_cvt_pk_bf16_f32 v92, v96, v97
    v_cvt_pk_bf16_f32 v93, v98, v99
    v_cvt_pk_bf16_f32 v94, v100, v101
    v_cvt_pk_bf16_f32 v95, v102, v103
    v_fmamk_f32 v104, v104, 0x3e0293ee, v24
    v_fmamk_f32 v105, v105, 0x3e0293ee, v24
    v_fmamk_f32 v106, v106, 0x3e0293ee, v24
    v_fmamk_f32 v107, v107, 0x3e0293ee, v24
    v_fmamk_f32 v108, v108, 0x3e0293ee, v24
    v_fmamk_f32 v109, v109, 0x3e0293ee, v24
    v_fmamk_f32 v110, v110, 0x3e0293ee, v24
    v_fmamk_f32 v111, v111, 0x3e0293ee, v24
    v_exp_f32 v104, v104
    v_exp_f32 v105, v105
    v_exp_f32 v106, v106
    v_exp_f32 v107, v107
    v_exp_f32 v108, v108
    v_exp_f32 v109, v109
    v_exp_f32 v110, v110
    v_exp_f32 v111, v111
    v_cvt_pk_bf16_f32 v96, v104, v105
    v_cvt_pk_bf16_f32 v97, v106, v107
    v_cvt_pk_bf16_f32 v98, v108, v109
    v_cvt_pk_bf16_f32 v99, v110, v111
    v_fmamk_f32 v112, v112, 0x3e0293ee, v24
    v_fmamk_f32 v113, v113, 0x3e0293ee, v24
    v_fmamk_f32 v114, v114, 0x3e0293ee, v24
    v_fmamk_f32 v115, v115, 0x3e0293ee, v24
    v_fmamk_f32 v116, v116, 0x3e0293ee, v24
    v_fmamk_f32 v117, v117, 0x3e0293ee, v24
    v_fmamk_f32 v118, v118, 0x3e0293ee, v24
    v_fmamk_f32 v119, v119, 0x3e0293ee, v24
    v_exp_f32 v112, v112
    v_exp_f32 v113, v113
    v_exp_f32 v114, v114
    v_exp_f32 v115, v115
    v_exp_f32 v116, v116
    v_exp_f32 v117, v117
    v_exp_f32 v118, v118
    v_exp_f32 v119, v119
    v_cvt_pk_bf16_f32 v100, v112, v113
    v_cvt_pk_bf16_f32 v101, v114, v115
    v_cvt_pk_bf16_f32 v102, v116, v117
    v_cvt_pk_bf16_f32 v103, v118, v119
    v_fmamk_f32 v120, v120, 0x3e0293ee, v24
    v_fmamk_f32 v121, v121, 0x3e0293ee, v24
    v_fmamk_f32 v122, v122, 0x3e0293ee, v24
    v_fmamk_f32 v123, v123, 0x3e0293ee, v24
    v_fmamk_f32 v124, v124, 0x3e0293ee, v24
    v_fmamk_f32 v125, v125, 0x3e0293ee, v24
    v_fmamk_f32 v126, v126, 0x3e0293ee, v24
    v_fmamk_f32 v127, v127, 0x3e0293ee, v24
    v_exp_f32 v120, v120
    v_exp_f32 v121, v121
    v_exp_f32 v122, v122
    v_exp_f32 v123, v123
    v_exp_f32 v124, v124
    v_exp_f32 v125, v125
    v_exp_f32 v126, v126
    v_exp_f32 v127, v127
    v_cvt_pk_bf16_f32 v104, v120, v121
    v_cvt_pk_bf16_f32 v105, v122, v123
    v_cvt_pk_bf16_f32 v106, v124, v125
    v_cvt_pk_bf16_f32 v107, v126, v127
    v_fmamk_f32 v128, v128, 0x3e0293ee, v24
    v_fmamk_f32 v129, v129, 0x3e0293ee, v24
    v_fmamk_f32 v130, v130, 0x3e0293ee, v24
    v_fmamk_f32 v131, v131, 0x3e0293ee, v24
    v_fmamk_f32 v132, v132, 0x3e0293ee, v24
    v_fmamk_f32 v133, v133, 0x3e0293ee, v24
    v_fmamk_f32 v134, v134, 0x3e0293ee, v24
    v_fmamk_f32 v135, v135, 0x3e0293ee, v24
    v_exp_f32 v128, v128
    v_exp_f32 v129, v129
    v_exp_f32 v130, v130
    v_exp_f32 v131, v131
    v_exp_f32 v132, v132
    v_exp_f32 v133, v133
    v_exp_f32 v134, v134
    v_exp_f32 v135, v135
    v_cvt_pk_bf16_f32 v108, v128, v129
    v_cvt_pk_bf16_f32 v109, v130, v131
    v_cvt_pk_bf16_f32 v110, v132, v133
    v_cvt_pk_bf16_f32 v111, v134, v135
    v_fmamk_f32 v136, v136, 0x3e0293ee, v24
    v_fmamk_f32 v137, v137, 0x3e0293ee, v24
    v_fmamk_f32 v138, v138, 0x3e0293ee, v24
    v_fmamk_f32 v139, v139, 0x3e0293ee, v24
    v_fmamk_f32 v140, v140, 0x3e0293ee, v24
    v_fmamk_f32 v141, v141, 0x3e0293ee, v24
    v_fmamk_f32 v142, v142, 0x3e0293ee, v24
    v_fmamk_f32 v143, v143, 0x3e0293ee, v24
    v_exp_f32 v136, v136
    v_exp_f32 v137, v137
    v_exp_f32 v138, v138
    v_exp_f32 v139, v139
    v_exp_f32 v140, v140
    v_exp_f32 v141, v141
    v_exp_f32 v142, v142
    v_exp_f32 v143, v143
    v_cvt_pk_bf16_f32 v112, v136, v137
    v_cvt_pk_bf16_f32 v113, v138, v139
    v_cvt_pk_bf16_f32 v114, v140, v141
    v_cvt_pk_bf16_f32 v115, v142, v143
    v_fmamk_f32 v144, v144, 0x3e0293ee, v24
    v_fmamk_f32 v145, v145, 0x3e0293ee, v24
    v_fmamk_f32 v146, v146, 0x3e0293ee, v24
    v_fmamk_f32 v147, v147, 0x3e0293ee, v24
    v_fmamk_f32 v148, v148, 0x3e0293ee, v24
    v_fmamk_f32 v149, v149, 0x3e0293ee, v24
    v_fmamk_f32 v150, v150, 0x3e0293ee, v24
    v_fmamk_f32 v151, v151, 0x3e0293ee, v24
    v_exp_f32 v144, v144
    v_exp_f32 v145, v145
    v_exp_f32 v146, v146
    v_exp_f32 v147, v147
    v_exp_f32 v148, v148
    v_exp_f32 v149, v149
    v_exp_f32 v150, v150
    v_exp_f32 v151, v151
    v_cvt_pk_bf16_f32 v116, v144, v145
    v_cvt_pk_bf16_f32 v117, v146, v147
    v_cvt_pk_bf16_f32 v118, v148, v149
    v_cvt_pk_bf16_f32 v119, v150, v151
    v_fmamk_f32 v152, v152, 0x3e0293ee, v24
    v_fmamk_f32 v153, v153, 0x3e0293ee, v24
    v_fmamk_f32 v154, v154, 0x3e0293ee, v24
    v_fmamk_f32 v155, v155, 0x3e0293ee, v24
    v_fmamk_f32 v156, v156, 0x3e0293ee, v24
    v_fmamk_f32 v157, v157, 0x3e0293ee, v24
    v_fmamk_f32 v158, v158, 0x3e0293ee, v24
    v_fmamk_f32 v159, v159, 0x3e0293ee, v24
    v_exp_f32 v152, v152
    v_exp_f32 v153, v153
    v_exp_f32 v154, v154
    v_exp_f32 v155, v155
    v_exp_f32 v156, v156
    v_exp_f32 v157, v157
    v_exp_f32 v158, v158
    v_exp_f32 v159, v159
    v_cvt_pk_bf16_f32 v120, v152, v153
    v_cvt_pk_bf16_f32 v121, v154, v155
    v_cvt_pk_bf16_f32 v122, v156, v157
    v_cvt_pk_bf16_f32 v123, v158, v159
    v_fmamk_f32 v160, v160, 0x3e0293ee, v24
    v_fmamk_f32 v161, v161, 0x3e0293ee, v24
    v_fmamk_f32 v162, v162, 0x3e0293ee, v24
    v_fmamk_f32 v163, v163, 0x3e0293ee, v24
    v_fmamk_f32 v164, v164, 0x3e0293ee, v24
    v_fmamk_f32 v165, v165, 0x3e0293ee, v24
    v_fmamk_f32 v166, v166, 0x3e0293ee, v24
    v_fmamk_f32 v167, v167, 0x3e0293ee, v24
    v_exp_f32 v160, v160
    v_exp_f32 v161, v161
    v_exp_f32 v162, v162
    v_exp_f32 v163, v163
    v_exp_f32 v164, v164
    v_exp_f32 v165, v165
    v_exp_f32 v166, v166
    v_exp_f32 v167, v167
    v_cvt_pk_bf16_f32 v124, v160, v161
    v_cvt_pk_bf16_f32 v125, v162, v163
    v_cvt_pk_bf16_f32 v126, v164, v165
    v_cvt_pk_bf16_f32 v127, v166, v167
    v_fmamk_f32 v168, v168, 0x3e0293ee, v24
    v_fmamk_f32 v169, v169, 0x3e0293ee, v24
    v_fmamk_f32 v170, v170, 0x3e0293ee, v24
    v_fmamk_f32 v171, v171, 0x3e0293ee, v24
    v_fmamk_f32 v172, v172, 0x3e0293ee, v24
    v_fmamk_f32 v173, v173, 0x3e0293ee, v24
    v_fmamk_f32 v174, v174, 0x3e0293ee, v24
    v_fmamk_f32 v175, v175, 0x3e0293ee, v24
    v_exp_f32 v168, v168
    v_exp_f32 v169, v169
    v_exp_f32 v170, v170
    v_exp_f32 v171, v171
    v_exp_f32 v172, v172
    v_exp_f32 v173, v173
    v_exp_f32 v174, v174
    v_exp_f32 v175, v175
    v_cvt_pk_bf16_f32 v168, v168, v169
    v_cvt_pk_bf16_f32 v169, v170, v171
    v_cvt_pk_bf16_f32 v170, v172, v173
    v_cvt_pk_bf16_f32 v171, v174, v175
    v_fmamk_f32 v176, v176, 0x3e0293ee, v24
    v_fmamk_f32 v177, v177, 0x3e0293ee, v24
    v_fmamk_f32 v178, v178, 0x3e0293ee, v24
    v_fmamk_f32 v179, v179, 0x3e0293ee, v24
    v_fmamk_f32 v180, v180, 0x3e0293ee, v24
    v_fmamk_f32 v181, v181, 0x3e0293ee, v24
    v_fmamk_f32 v182, v182, 0x3e0293ee, v24
    v_fmamk_f32 v183, v183, 0x3e0293ee, v24
    v_exp_f32 v176, v176
    v_exp_f32 v177, v177
    v_exp_f32 v178, v178
    v_exp_f32 v179, v179
    v_exp_f32 v180, v180
    v_exp_f32 v181, v181
    v_exp_f32 v182, v182
    v_exp_f32 v183, v183
    v_cvt_pk_bf16_f32 v172, v176, v177
    v_cvt_pk_bf16_f32 v173, v178, v179
    v_cvt_pk_bf16_f32 v174, v180, v181
    v_cvt_pk_bf16_f32 v175, v182, v183
    v_fmamk_f32 v184, v184, 0x3e0293ee, v24
    v_fmamk_f32 v185, v185, 0x3e0293ee, v24
    v_fmamk_f32 v186, v186, 0x3e0293ee, v24
    v_fmamk_f32 v187, v187, 0x3e0293ee, v24
    v_fmamk_f32 v188, v188, 0x3e0293ee, v24
    v_fmamk_f32 v189, v189, 0x3e0293ee, v24
    v_fmamk_f32 v190, v190, 0x3e0293ee, v24
    v_fmamk_f32 v191, v191, 0x3e0293ee, v24
    v_exp_f32 v184, v184
    v_exp_f32 v185, v185
    v_exp_f32 v186, v186
    v_exp_f32 v187, v187
    v_exp_f32 v188, v188
    v_exp_f32 v189, v189
    v_exp_f32 v190, v190
    v_exp_f32 v191, v191
    v_cvt_pk_bf16_f32 v176, v184, v185
    v_cvt_pk_bf16_f32 v177, v186, v187
    v_cvt_pk_bf16_f32 v178, v188, v189
    v_cvt_pk_bf16_f32 v179, v190, v191
    v_fmamk_f32 v192, v192, 0x3e0293ee, v24
    v_fmamk_f32 v193, v193, 0x3e0293ee, v24
    v_fmamk_f32 v194, v194, 0x3e0293ee, v24
    v_fmamk_f32 v195, v195, 0x3e0293ee, v24
    v_fmamk_f32 v196, v196, 0x3e0293ee, v24
    v_fmamk_f32 v197, v197, 0x3e0293ee, v24
    v_fmamk_f32 v198, v198, 0x3e0293ee, v24
    v_fmamk_f32 v199, v199, 0x3e0293ee, v24
    v_exp_f32 v192, v192
    v_exp_f32 v193, v193
    v_exp_f32 v194, v194
    v_exp_f32 v195, v195
    v_exp_f32 v196, v196
    v_exp_f32 v197, v197
    v_exp_f32 v198, v198
    v_exp_f32 v199, v199
    v_cvt_pk_bf16_f32 v180, v192, v193
    v_cvt_pk_bf16_f32 v181, v194, v195
    v_cvt_pk_bf16_f32 v182, v196, v197
    v_cvt_pk_bf16_f32 v183, v198, v199
    v_fmamk_f32 v200, v200, 0x3e0293ee, v24
    v_fmamk_f32 v201, v201, 0x3e0293ee, v24
    v_fmamk_f32 v202, v202, 0x3e0293ee, v24
    v_fmamk_f32 v203, v203, 0x3e0293ee, v24
    v_fmamk_f32 v204, v204, 0x3e0293ee, v24
    v_fmamk_f32 v205, v205, 0x3e0293ee, v24
    v_fmamk_f32 v206, v206, 0x3e0293ee, v24
    v_fmamk_f32 v207, v207, 0x3e0293ee, v24
    v_exp_f32 v200, v200
    v_exp_f32 v201, v201
    v_exp_f32 v202, v202
    v_exp_f32 v203, v203
    v_exp_f32 v204, v204
    v_exp_f32 v205, v205
    v_exp_f32 v206, v206
    v_exp_f32 v207, v207
    v_cvt_pk_bf16_f32 v184, v200, v201
    v_cvt_pk_bf16_f32 v185, v202, v203
    v_cvt_pk_bf16_f32 v186, v204, v205
    v_cvt_pk_bf16_f32 v187, v206, v207
    v_fmamk_f32 v208, v208, 0x3e0293ee, v24
    v_fmamk_f32 v209, v209, 0x3e0293ee, v24
    v_fmamk_f32 v210, v210, 0x3e0293ee, v24
    v_fmamk_f32 v211, v211, 0x3e0293ee, v24
    v_fmamk_f32 v212, v212, 0x3e0293ee, v24
    v_fmamk_f32 v213, v213, 0x3e0293ee, v24
    v_fmamk_f32 v214, v214, 0x3e0293ee, v24
    v_fmamk_f32 v215, v215, 0x3e0293ee, v24
    v_exp_f32 v208, v208
    v_exp_f32 v209, v209
    v_exp_f32 v210, v210
    v_exp_f32 v211, v211
    v_exp_f32 v212, v212
    v_exp_f32 v213, v213
    v_exp_f32 v214, v214
    v_exp_f32 v215, v215
    v_cvt_pk_bf16_f32 v188, v208, v209
    v_cvt_pk_bf16_f32 v189, v210, v211
    v_cvt_pk_bf16_f32 v190, v212, v213
    v_cvt_pk_bf16_f32 v191, v214, v215
    v_fmamk_f32 v216, v216, 0x3e0293ee, v24
    v_fmamk_f32 v217, v217, 0x3e0293ee, v24
    v_fmamk_f32 v218, v218, 0x3e0293ee, v24
    v_fmamk_f32 v219, v219, 0x3e0293ee, v24
    v_fmamk_f32 v220, v220, 0x3e0293ee, v24
    v_fmamk_f32 v221, v221, 0x3e0293ee, v24
    v_fmamk_f32 v222, v222, 0x3e0293ee, v24
    v_fmamk_f32 v223, v223, 0x3e0293ee, v24
    v_exp_f32 v216, v216
    v_exp_f32 v217, v217
    v_exp_f32 v218, v218
    v_exp_f32 v219, v219
    v_exp_f32 v220, v220
    v_exp_f32 v221, v221
    v_exp_f32 v222, v222
    v_exp_f32 v223, v223
    v_cvt_pk_bf16_f32 v192, v216, v217
    v_cvt_pk_bf16_f32 v193, v218, v219
    v_cvt_pk_bf16_f32 v194, v220, v221
    v_cvt_pk_bf16_f32 v195, v222, v223
    v_fmamk_f32 v224, v224, 0x3e0293ee, v24
    v_fmamk_f32 v225, v225, 0x3e0293ee, v24
    v_fmamk_f32 v226, v226, 0x3e0293ee, v24
    v_fmamk_f32 v227, v227, 0x3e0293ee, v24
    v_fmamk_f32 v228, v228, 0x3e0293ee, v24
    v_fmamk_f32 v229, v229, 0x3e0293ee, v24
    v_fmamk_f32 v230, v230, 0x3e0293ee, v24
    v_fmamk_f32 v231, v231, 0x3e0293ee, v24
    v_exp_f32 v224, v224
    v_exp_f32 v225, v225
    v_exp_f32 v226, v226
    v_exp_f32 v227, v227
    v_exp_f32 v228, v228
    v_exp_f32 v229, v229
    v_exp_f32 v230, v230
    v_exp_f32 v231, v231
    v_cvt_pk_bf16_f32 v196, v224, v225
    v_cvt_pk_bf16_f32 v197, v226, v227
    v_cvt_pk_bf16_f32 v198, v228, v229
    v_cvt_pk_bf16_f32 v199, v230, v231
    v_fmamk_f32 v232, v232, 0x3e0293ee, v24
    v_fmamk_f32 v233, v233, 0x3e0293ee, v24
    v_fmamk_f32 v234, v234, 0x3e0293ee, v24
    v_fmamk_f32 v235, v235, 0x3e0293ee, v24
    v_fmamk_f32 v236, v236, 0x3e0293ee, v24
    v_fmamk_f32 v237, v237, 0x3e0293ee, v24
    v_fmamk_f32 v238, v238, 0x3e0293ee, v24
    v_fmamk_f32 v239, v239, 0x3e0293ee, v24
    v_exp_f32 v232, v232
    v_exp_f32 v233, v233
    v_exp_f32 v234, v234
    v_exp_f32 v235, v235
    v_exp_f32 v236, v236
    v_exp_f32 v237, v237
    v_exp_f32 v238, v238
    v_exp_f32 v239, v239
    v_cvt_pk_bf16_f32 v200, v232, v233
    v_cvt_pk_bf16_f32 v201, v234, v235
    v_cvt_pk_bf16_f32 v202, v236, v237
    v_cvt_pk_bf16_f32 v203, v238, v239
    v_fmamk_f32 v240, v240, 0x3e0293ee, v24
    v_fmamk_f32 v241, v241, 0x3e0293ee, v24
    v_fmamk_f32 v242, v242, 0x3e0293ee, v24
    v_fmamk_f32 v243, v243, 0x3e0293ee, v24
    v_fmamk_f32 v244, v244, 0x3e0293ee, v24
    v_fmamk_f32 v245, v245, 0x3e0293ee, v24
    v_fmamk_f32 v246, v246, 0x3e0293ee, v24
    v_fmamk_f32 v247, v247, 0x3e0293ee, v24
    v_exp_f32 v240, v240
    v_exp_f32 v241, v241
    v_exp_f32 v242, v242
    v_exp_f32 v243, v243
    v_exp_f32 v244, v244
    v_exp_f32 v245, v245
    v_exp_f32 v246, v246
    v_exp_f32 v247, v247
    v_cvt_pk_bf16_f32 v204, v240, v241
    v_cvt_pk_bf16_f32 v205, v242, v243
    v_cvt_pk_bf16_f32 v206, v244, v245
    v_cvt_pk_bf16_f32 v207, v246, v247
    s_setprio 2
    ds_read_b64_tr_b16 v[40:41], v16 offset:0
    ds_read_b64_tr_b16 v[42:43], v16 offset:2048
    ds_read_b64_tr_b16 v[44:45], v16 offset:4096
    ds_read_b64_tr_b16 v[46:47], v16 offset:6144
    ds_read_b64_tr_b16 v[48:49], v16 offset:8192
    ds_read_b64_tr_b16 v[50:51], v16 offset:10240
    ds_read_b64_tr_b16 v[52:53], v16 offset:12288
    ds_read_b64_tr_b16 v[54:55], v16 offset:14336
    ds_read_b64_tr_b16 v[32:33], v16 offset:16384
    ds_read_b64_tr_b16 v[34:35], v16 offset:18432
    s_waitcnt lgkmcnt(6)
    v_mfma_f32_32x32x16_bf16 v[56:71], v[40:43], v[88:91], 0
    v_mfma_f32_16x16x32_bf16 v[12:15], v[8:11], v[88:91], 0
    ds_read_b64_tr_b16 v[36:37], v16 offset:20480
    ds_read_b64_tr_b16 v[38:39], v16 offset:22528
    v_mfma_f32_32x32x16_bf16 v[56:71], v[44:47], v[92:95], v[56:71]
    v_mfma_f32_16x16x32_bf16 v[12:15], v[8:11], v[92:95], v[12:15]
    ds_read_b64_tr_b16 v[40:41], v16 offset:24576
    ds_read_b64_tr_b16 v[42:43], v16 offset:26624
    s_waitcnt lgkmcnt(6)
    v_mfma_f32_32x32x16_bf16 v[56:71], v[48:51], v[96:99], v[56:71]
    v_mfma_f32_16x16x32_bf16 v[12:15], v[8:11], v[96:99], v[12:15]
    ds_read_b64_tr_b16 v[44:45], v16 offset:28672
    ds_read_b64_tr_b16 v[46:47], v16 offset:30720
    v_mfma_f32_32x32x16_bf16 v[56:71], v[52:55], v[100:103], v[56:71]
    v_mfma_f32_16x16x32_bf16 v[12:15], v[8:11], v[100:103], v[12:15]
    ds_read_b64_tr_b16 v[48:49], v16 offset:32768
    ds_read_b64_tr_b16 v[50:51], v16 offset:34816
    s_waitcnt lgkmcnt(6)
    v_mfma_f32_32x32x16_bf16 v[56:71], v[32:35], v[104:107], v[56:71]
    v_mfma_f32_16x16x32_bf16 v[12:15], v[8:11], v[104:107], v[12:15]
    ds_read_b64_tr_b16 v[52:53], v16 offset:36864
    ds_read_b64_tr_b16 v[54:55], v16 offset:38912
    v_mfma_f32_32x32x16_bf16 v[56:71], v[36:39], v[108:111], v[56:71]
    v_mfma_f32_16x16x32_bf16 v[12:15], v[8:11], v[108:111], v[12:15]
    v_add_u32 v16, 0xa000, v16
    ds_read_b64_tr_b16 v[32:33], v16 offset:0
    ds_read_b64_tr_b16 v[34:35], v16 offset:2048
    s_waitcnt lgkmcnt(6)
    v_mfma_f32_32x32x16_bf16 v[56:71], v[40:43], v[112:115], v[56:71]
    v_mfma_f32_16x16x32_bf16 v[12:15], v[8:11], v[112:115], v[12:15]
    ds_read_b64_tr_b16 v[36:37], v16 offset:4096
    ds_read_b64_tr_b16 v[38:39], v16 offset:6144
    v_mfma_f32_32x32x16_bf16 v[56:71], v[44:47], v[116:119], v[56:71]
    v_mfma_f32_16x16x32_bf16 v[12:15], v[8:11], v[116:119], v[12:15]
    ds_read_b64_tr_b16 v[40:41], v16 offset:8192
    ds_read_b64_tr_b16 v[42:43], v16 offset:10240
    s_waitcnt lgkmcnt(6)
    v_mfma_f32_32x32x16_bf16 v[56:71], v[48:51], v[120:123], v[56:71]
    v_mfma_f32_16x16x32_bf16 v[12:15], v[8:11], v[120:123], v[12:15]
    ds_read_b64_tr_b16 v[44:45], v16 offset:12288
    ds_read_b64_tr_b16 v[46:47], v16 offset:14336
    v_mfma_f32_32x32x16_bf16 v[56:71], v[52:55], v[124:127], v[56:71]
    v_mfma_f32_16x16x32_bf16 v[12:15], v[8:11], v[124:127], v[12:15]
    ds_read_b64_tr_b16 v[48:49], v16 offset:16384
    ds_read_b64_tr_b16 v[50:51], v16 offset:18432
    s_waitcnt lgkmcnt(6)
    v_mfma_f32_32x32x16_bf16 v[56:71], v[32:35], v[168:171], v[56:71]
    v_mfma_f32_16x16x32_bf16 v[12:15], v[8:11], v[168:171], v[12:15]
    ds_read_b64_tr_b16 v[52:53], v16 offset:20480
    ds_read_b64_tr_b16 v[54:55], v16 offset:22528
    v_mfma_f32_32x32x16_bf16 v[56:71], v[36:39], v[172:175], v[56:71]
    v_mfma_f32_16x16x32_bf16 v[12:15], v[8:11], v[172:175], v[12:15]
    ds_read_b64_tr_b16 v[32:33], v16 offset:24576
    ds_read_b64_tr_b16 v[34:35], v16 offset:26624
    s_waitcnt lgkmcnt(6)
    v_mfma_f32_32x32x16_bf16 v[56:71], v[40:43], v[176:179], v[56:71]
    v_mfma_f32_16x16x32_bf16 v[12:15], v[8:11], v[176:179], v[12:15]
    ds_read_b64_tr_b16 v[36:37], v16 offset:28672
    ds_read_b64_tr_b16 v[38:39], v16 offset:30720
    v_mfma_f32_32x32x16_bf16 v[56:71], v[44:47], v[180:183], v[56:71]
    v_mfma_f32_16x16x32_bf16 v[12:15], v[8:11], v[180:183], v[12:15]
    ds_read_b64_tr_b16 v[40:41], v16 offset:32768
    ds_read_b64_tr_b16 v[42:43], v16 offset:34816
    s_waitcnt lgkmcnt(6)
    v_mfma_f32_32x32x16_bf16 v[56:71], v[48:51], v[184:187], v[56:71]
    v_mfma_f32_16x16x32_bf16 v[12:15], v[8:11], v[184:187], v[12:15]
    ds_read_b64_tr_b16 v[44:45], v16 offset:36864
    ds_read_b64_tr_b16 v[46:47], v16 offset:38912
    v_mfma_f32_32x32x16_bf16 v[56:71], v[52:55], v[188:191], v[56:71]
    v_mfma_f32_16x16x32_bf16 v[12:15], v[8:11], v[188:191], v[12:15]
    ds_read_b64_tr_b16 v[48:49], v17 offset:0
    ds_read_b64_tr_b16 v[50:51], v17 offset:2048
    s_waitcnt lgkmcnt(6)
    v_mfma_f32_32x32x16_bf16 v[56:71], v[32:35], v[192:195], v[56:71]
    v_mfma_f32_16x16x32_bf16 v[12:15], v[8:11], v[192:195], v[12:15]
    ds_read_b64_tr_b16 v[52:53], v17 offset:4096
    ds_read_b64_tr_b16 v[54:55], v17 offset:6144
    v_mfma_f32_32x32x16_bf16 v[56:71], v[36:39], v[196:199], v[56:71]
    v_mfma_f32_16x16x32_bf16 v[12:15], v[8:11], v[196:199], v[12:15]
    ds_read_b64_tr_b16 v[32:33], v17 offset:8192
    ds_read_b64_tr_b16 v[34:35], v17 offset:10240
    s_waitcnt lgkmcnt(6)
    v_mfma_f32_32x32x16_bf16 v[56:71], v[40:43], v[200:203], v[56:71]
    v_mfma_f32_16x16x32_bf16 v[12:15], v[8:11], v[200:203], v[12:15]
    ds_read_b64_tr_b16 v[36:37], v17 offset:12288
    ds_read_b64_tr_b16 v[38:39], v17 offset:14336
    v_mfma_f32_32x32x16_bf16 v[56:71], v[44:47], v[204:207], v[56:71]
    v_mfma_f32_16x16x32_bf16 v[12:15], v[8:11], v[204:207], v[12:15]
    ds_read_b64_tr_b16 v[40:41], v17 offset:16384
    ds_read_b64_tr_b16 v[42:43], v17 offset:18432
    s_waitcnt lgkmcnt(6)
    v_mfma_f32_32x32x16_bf16 v[72:87], v[48:51], v[88:91], 0
    ds_read_b64_tr_b16 v[44:45], v17 offset:20480
    ds_read_b64_tr_b16 v[46:47], v17 offset:22528
    v_mfma_f32_32x32x16_bf16 v[72:87], v[52:55], v[92:95], v[72:87]
    ds_read_b64_tr_b16 v[48:49], v17 offset:24576
    ds_read_b64_tr_b16 v[50:51], v17 offset:26624
    s_waitcnt lgkmcnt(6)
    v_mfma_f32_32x32x16_bf16 v[72:87], v[32:35], v[96:99], v[72:87]
    ds_read_b64_tr_b16 v[52:53], v17 offset:28672
    ds_read_b64_tr_b16 v[54:55], v17 offset:30720
    v_mfma_f32_32x32x16_bf16 v[72:87], v[36:39], v[100:103], v[72:87]
    v_rcp_f32 v25, v12
    s_nop 0
    v_mul_f32 v56, v56, v25
    v_mul_f32 v57, v57, v25
    v_mul_f32 v58, v58, v25
    v_mul_f32 v59, v59, v25
    v_mul_f32 v60, v60, v25
    v_mul_f32 v61, v61, v25
    ds_read_b64_tr_b16 v[32:33], v17 offset:32768
    ds_read_b64_tr_b16 v[34:35], v17 offset:34816
    s_waitcnt lgkmcnt(6)
    v_mfma_f32_32x32x16_bf16 v[72:87], v[40:43], v[104:107], v[72:87]
    v_mul_f32 v62, v62, v25
    v_mul_f32 v63, v63, v25
    v_mul_f32 v64, v64, v25
    v_mul_f32 v65, v65, v25
    v_mul_f32 v66, v66, v25
    v_mul_f32 v67, v67, v25
    v_mul_f32 v68, v68, v25
    v_mul_f32 v69, v69, v25
    ds_read_b64_tr_b16 v[36:37], v17 offset:36864
    ds_read_b64_tr_b16 v[38:39], v17 offset:38912
    v_mfma_f32_32x32x16_bf16 v[72:87], v[44:47], v[108:111], v[72:87]
    v_mul_f32 v70, v70, v25
    v_mul_f32 v71, v71, v25
    v_cvt_pk_bf16_f32 v56, v56, v57
    v_cvt_pk_bf16_f32 v57, v58, v59
    v_cvt_pk_bf16_f32 v58, v60, v61
    v_cvt_pk_bf16_f32 v59, v62, v63
    v_cvt_pk_bf16_f32 v60, v64, v65
    v_cvt_pk_bf16_f32 v61, v66, v67
    v_add_u32 v17, 0xa000, v17
    ds_read_b64_tr_b16 v[40:41], v17 offset:0
    ds_read_b64_tr_b16 v[42:43], v17 offset:2048
    s_waitcnt lgkmcnt(6)
    v_mfma_f32_32x32x16_bf16 v[72:87], v[48:51], v[112:115], v[72:87]
    v_cvt_pk_bf16_f32 v62, v68, v69
    v_cvt_pk_bf16_f32 v63, v70, v71
    ds_read_b64_tr_b16 v[44:45], v17 offset:4096
    ds_read_b64_tr_b16 v[46:47], v17 offset:6144
    v_mfma_f32_32x32x16_bf16 v[72:87], v[52:55], v[116:119], v[72:87]
    ds_read_b64_tr_b16 v[48:49], v17 offset:8192
    ds_read_b64_tr_b16 v[50:51], v17 offset:10240
    s_waitcnt lgkmcnt(6)
    v_mfma_f32_32x32x16_bf16 v[72:87], v[32:35], v[120:123], v[72:87]
    ds_read_b64_tr_b16 v[52:53], v17 offset:12288
    ds_read_b64_tr_b16 v[54:55], v17 offset:14336
    v_mfma_f32_32x32x16_bf16 v[72:87], v[36:39], v[124:127], v[72:87]
    ds_read_b64_tr_b16 v[32:33], v17 offset:16384
    ds_read_b64_tr_b16 v[34:35], v17 offset:18432
    s_waitcnt lgkmcnt(6)
    v_mfma_f32_32x32x16_bf16 v[72:87], v[40:43], v[168:171], v[72:87]
    ds_read_b64_tr_b16 v[36:37], v17 offset:20480
    ds_read_b64_tr_b16 v[38:39], v17 offset:22528
    v_mfma_f32_32x32x16_bf16 v[72:87], v[44:47], v[172:175], v[72:87]
    ds_read_b64_tr_b16 v[40:41], v17 offset:24576
    ds_read_b64_tr_b16 v[42:43], v17 offset:26624
    s_waitcnt lgkmcnt(6)
    v_mfma_f32_32x32x16_bf16 v[72:87], v[48:51], v[176:179], v[72:87]
    ds_read_b64_tr_b16 v[44:45], v17 offset:28672
    ds_read_b64_tr_b16 v[46:47], v17 offset:30720
    v_mfma_f32_32x32x16_bf16 v[72:87], v[52:55], v[180:183], v[72:87]
    ds_read_b64_tr_b16 v[48:49], v17 offset:32768
    ds_read_b64_tr_b16 v[50:51], v17 offset:34816
    s_waitcnt lgkmcnt(6)
    v_mfma_f32_32x32x16_bf16 v[72:87], v[32:35], v[184:187], v[72:87]
    ds_read_b64_tr_b16 v[52:53], v17 offset:36864
    ds_read_b64_tr_b16 v[54:55], v17 offset:38912
    v_mfma_f32_32x32x16_bf16 v[72:87], v[36:39], v[188:191], v[72:87]
    ds_read_b64_tr_b16 v[32:33], v18 offset:0
    ds_read_b64_tr_b16 v[34:35], v18 offset:2048
    s_waitcnt lgkmcnt(6)
    v_mfma_f32_32x32x16_bf16 v[72:87], v[40:43], v[192:195], v[72:87]
    ds_read_b64_tr_b16 v[36:37], v18 offset:4096
    ds_read_b64_tr_b16 v[38:39], v18 offset:6144
    v_mfma_f32_32x32x16_bf16 v[72:87], v[44:47], v[196:199], v[72:87]
    ds_read_b64_tr_b16 v[40:41], v18 offset:8192
    ds_read_b64_tr_b16 v[42:43], v18 offset:10240
    s_waitcnt lgkmcnt(6)
    v_mfma_f32_32x32x16_bf16 v[72:87], v[48:51], v[200:203], v[72:87]
    ds_read_b64_tr_b16 v[44:45], v18 offset:12288
    ds_read_b64_tr_b16 v[46:47], v18 offset:14336
    v_mfma_f32_32x32x16_bf16 v[72:87], v[52:55], v[204:207], v[72:87]
    ds_read_b64_tr_b16 v[48:49], v18 offset:16384
    ds_read_b64_tr_b16 v[50:51], v18 offset:18432
    s_waitcnt lgkmcnt(6)
    v_mfma_f32_32x32x16_bf16 v[136:151], v[32:35], v[88:91], 0
    ds_read_b64_tr_b16 v[52:53], v18 offset:20480
    ds_read_b64_tr_b16 v[54:55], v18 offset:22528
    v_mfma_f32_32x32x16_bf16 v[136:151], v[36:39], v[92:95], v[136:151]
    ds_read_b64_tr_b16 v[32:33], v18 offset:24576
    ds_read_b64_tr_b16 v[34:35], v18 offset:26624
    s_waitcnt lgkmcnt(6)
    v_mfma_f32_32x32x16_bf16 v[136:151], v[40:43], v[96:99], v[136:151]
    ds_read_b64_tr_b16 v[36:37], v18 offset:28672
    ds_read_b64_tr_b16 v[38:39], v18 offset:30720
    v_mfma_f32_32x32x16_bf16 v[136:151], v[44:47], v[100:103], v[136:151]
    ds_read_b64_tr_b16 v[40:41], v18 offset:32768
    ds_read_b64_tr_b16 v[42:43], v18 offset:34816
    s_waitcnt lgkmcnt(6)
    v_mfma_f32_32x32x16_bf16 v[136:151], v[48:51], v[104:107], v[136:151]
    v_mul_f32 v72, v72, v25
    v_mul_f32 v73, v73, v25
    v_mul_f32 v74, v74, v25
    v_mul_f32 v75, v75, v25
    v_mul_f32 v76, v76, v25
    v_mul_f32 v77, v77, v25
    v_mul_f32 v78, v78, v25
    v_mul_f32 v79, v79, v25
    ds_read_b64_tr_b16 v[44:45], v18 offset:36864
    ds_read_b64_tr_b16 v[46:47], v18 offset:38912
    v_mfma_f32_32x32x16_bf16 v[136:151], v[52:55], v[108:111], v[136:151]
    v_mul_f32 v80, v80, v25
    v_mul_f32 v81, v81, v25
    v_mul_f32 v82, v82, v25
    v_mul_f32 v83, v83, v25
    v_mul_f32 v84, v84, v25
    v_mul_f32 v85, v85, v25
    v_mul_f32 v86, v86, v25
    v_mul_f32 v87, v87, v25
    v_add_u32 v18, 0xa000, v18
    ds_read_b64_tr_b16 v[48:49], v18 offset:0
    ds_read_b64_tr_b16 v[50:51], v18 offset:2048
    s_waitcnt lgkmcnt(6)
    v_mfma_f32_32x32x16_bf16 v[136:151], v[32:35], v[112:115], v[136:151]
    v_cvt_pk_bf16_f32 v72, v72, v73
    v_cvt_pk_bf16_f32 v73, v74, v75
    v_cvt_pk_bf16_f32 v74, v76, v77
    v_cvt_pk_bf16_f32 v75, v78, v79
    v_cvt_pk_bf16_f32 v76, v80, v81
    v_cvt_pk_bf16_f32 v77, v82, v83
    v_cvt_pk_bf16_f32 v78, v84, v85
    v_cvt_pk_bf16_f32 v79, v86, v87
    ds_read_b64_tr_b16 v[52:53], v18 offset:4096
    ds_read_b64_tr_b16 v[54:55], v18 offset:6144
    v_mfma_f32_32x32x16_bf16 v[136:151], v[36:39], v[116:119], v[136:151]
    v_permlane16_swap_b32 v56, v72
    v_permlane16_swap_b32 v57, v73
    v_permlane16_swap_b32 v58, v74
    v_permlane16_swap_b32 v59, v75
    v_permlane16_swap_b32 v60, v76
    v_permlane16_swap_b32 v61, v77
    v_permlane16_swap_b32 v62, v78
    v_permlane16_swap_b32 v63, v79
    ds_read_b64_tr_b16 v[32:33], v18 offset:8192
    ds_read_b64_tr_b16 v[34:35], v18 offset:10240
    s_waitcnt lgkmcnt(6)
    v_mfma_f32_32x32x16_bf16 v[136:151], v[40:43], v[120:123], v[136:151]
    buffer_store_dwordx4 v[56:59], v20, s[24:27], s30 offen offset:0 sc1 nt
    buffer_store_dwordx4 v[72:75], v21, s[24:27], s30 offen offset:0 sc1 nt
    buffer_store_dwordx4 v[60:63], v20, s[24:27], s30 offen offset:128 sc1 nt
    buffer_store_dwordx4 v[76:79], v21, s[24:27], s30 offen offset:128 sc1 nt
    ds_read_b64_tr_b16 v[36:37], v18 offset:12288
    ds_read_b64_tr_b16 v[38:39], v18 offset:14336
    v_mfma_f32_32x32x16_bf16 v[136:151], v[44:47], v[124:127], v[136:151]
    ds_read_b64_tr_b16 v[40:41], v18 offset:16384
    ds_read_b64_tr_b16 v[42:43], v18 offset:18432
    s_waitcnt lgkmcnt(6)
    v_mfma_f32_32x32x16_bf16 v[136:151], v[48:51], v[168:171], v[136:151]
    ds_read_b64_tr_b16 v[44:45], v18 offset:20480
    ds_read_b64_tr_b16 v[46:47], v18 offset:22528
    v_mfma_f32_32x32x16_bf16 v[136:151], v[52:55], v[172:175], v[136:151]
    ds_read_b64_tr_b16 v[48:49], v18 offset:24576
    ds_read_b64_tr_b16 v[50:51], v18 offset:26624
    s_waitcnt lgkmcnt(6)
    v_mfma_f32_32x32x16_bf16 v[136:151], v[32:35], v[176:179], v[136:151]
    ds_read_b64_tr_b16 v[52:53], v18 offset:28672
    ds_read_b64_tr_b16 v[54:55], v18 offset:30720
    v_mfma_f32_32x32x16_bf16 v[136:151], v[36:39], v[180:183], v[136:151]
    ds_read_b64_tr_b16 v[32:33], v18 offset:32768
    ds_read_b64_tr_b16 v[34:35], v18 offset:34816
    s_waitcnt lgkmcnt(6)
    v_mfma_f32_32x32x16_bf16 v[136:151], v[40:43], v[184:187], v[136:151]
    ds_read_b64_tr_b16 v[36:37], v18 offset:36864
    ds_read_b64_tr_b16 v[38:39], v18 offset:38912
    v_mfma_f32_32x32x16_bf16 v[136:151], v[44:47], v[188:191], v[136:151]
    ds_read_b64_tr_b16 v[40:41], v19 offset:0
    ds_read_b64_tr_b16 v[42:43], v19 offset:2048
    s_waitcnt lgkmcnt(6)
    v_mfma_f32_32x32x16_bf16 v[136:151], v[48:51], v[192:195], v[136:151]
    ds_read_b64_tr_b16 v[44:45], v19 offset:4096
    ds_read_b64_tr_b16 v[46:47], v19 offset:6144
    v_mfma_f32_32x32x16_bf16 v[136:151], v[52:55], v[196:199], v[136:151]
    ds_read_b64_tr_b16 v[48:49], v19 offset:8192
    ds_read_b64_tr_b16 v[50:51], v19 offset:10240
    s_waitcnt lgkmcnt(6)
    v_mfma_f32_32x32x16_bf16 v[136:151], v[32:35], v[200:203], v[136:151]
    ds_read_b64_tr_b16 v[52:53], v19 offset:12288
    ds_read_b64_tr_b16 v[54:55], v19 offset:14336
    v_mfma_f32_32x32x16_bf16 v[136:151], v[36:39], v[204:207], v[136:151]
    ds_read_b64_tr_b16 v[32:33], v19 offset:16384
    ds_read_b64_tr_b16 v[34:35], v19 offset:18432
    s_waitcnt lgkmcnt(6)
    v_mfma_f32_32x32x16_bf16 v[152:167], v[40:43], v[88:91], 0
    ds_read_b64_tr_b16 v[36:37], v19 offset:20480
    ds_read_b64_tr_b16 v[38:39], v19 offset:22528
    v_mfma_f32_32x32x16_bf16 v[152:167], v[44:47], v[92:95], v[152:167]
    ds_read_b64_tr_b16 v[40:41], v19 offset:24576
    ds_read_b64_tr_b16 v[42:43], v19 offset:26624
    s_waitcnt lgkmcnt(6)
    v_mfma_f32_32x32x16_bf16 v[152:167], v[48:51], v[96:99], v[152:167]
    ds_read_b64_tr_b16 v[44:45], v19 offset:28672
    ds_read_b64_tr_b16 v[46:47], v19 offset:30720
    v_mfma_f32_32x32x16_bf16 v[152:167], v[52:55], v[100:103], v[152:167]
    ds_read_b64_tr_b16 v[48:49], v19 offset:32768
    ds_read_b64_tr_b16 v[50:51], v19 offset:34816
    s_waitcnt lgkmcnt(6)
    v_mfma_f32_32x32x16_bf16 v[152:167], v[32:35], v[104:107], v[152:167]
    v_mul_f32 v136, v136, v25
    v_mul_f32 v137, v137, v25
    v_mul_f32 v138, v138, v25
    v_mul_f32 v139, v139, v25
    v_mul_f32 v140, v140, v25
    v_mul_f32 v141, v141, v25
    v_mul_f32 v142, v142, v25
    v_mul_f32 v143, v143, v25
    ds_read_b64_tr_b16 v[52:53], v19 offset:36864
    ds_read_b64_tr_b16 v[54:55], v19 offset:38912
    v_mfma_f32_32x32x16_bf16 v[152:167], v[36:39], v[108:111], v[152:167]
    v_mul_f32 v144, v144, v25
    v_mul_f32 v145, v145, v25
    v_mul_f32 v146, v146, v25
    v_mul_f32 v147, v147, v25
    v_mul_f32 v148, v148, v25
    v_mul_f32 v149, v149, v25
    v_mul_f32 v150, v150, v25
    v_mul_f32 v151, v151, v25
    v_add_u32 v19, 0xa000, v19
    ds_read_b64_tr_b16 v[32:33], v19 offset:0
    ds_read_b64_tr_b16 v[34:35], v19 offset:2048
    s_waitcnt lgkmcnt(6)
    v_mfma_f32_32x32x16_bf16 v[152:167], v[40:43], v[112:115], v[152:167]
    v_cvt_pk_bf16_f32 v136, v136, v137
    v_cvt_pk_bf16_f32 v137, v138, v139
    v_cvt_pk_bf16_f32 v138, v140, v141
    v_cvt_pk_bf16_f32 v139, v142, v143
    v_cvt_pk_bf16_f32 v140, v144, v145
    v_cvt_pk_bf16_f32 v141, v146, v147
    v_cvt_pk_bf16_f32 v142, v148, v149
    v_cvt_pk_bf16_f32 v143, v150, v151
    ds_read_b64_tr_b16 v[36:37], v19 offset:4096
    ds_read_b64_tr_b16 v[38:39], v19 offset:6144
    v_mfma_f32_32x32x16_bf16 v[152:167], v[44:47], v[116:119], v[152:167]
    ds_read_b64_tr_b16 v[40:41], v19 offset:8192
    ds_read_b64_tr_b16 v[42:43], v19 offset:10240
    s_waitcnt lgkmcnt(6)
    v_mfma_f32_32x32x16_bf16 v[152:167], v[48:51], v[120:123], v[152:167]
    ds_read_b64_tr_b16 v[44:45], v19 offset:12288
    ds_read_b64_tr_b16 v[46:47], v19 offset:14336
    v_mfma_f32_32x32x16_bf16 v[152:167], v[52:55], v[124:127], v[152:167]
    ds_read_b64_tr_b16 v[48:49], v19 offset:16384
    ds_read_b64_tr_b16 v[50:51], v19 offset:18432
    s_waitcnt lgkmcnt(6)
    v_mfma_f32_32x32x16_bf16 v[152:167], v[32:35], v[168:171], v[152:167]
    ds_read_b64_tr_b16 v[52:53], v19 offset:20480
    ds_read_b64_tr_b16 v[54:55], v19 offset:22528
    v_mfma_f32_32x32x16_bf16 v[152:167], v[36:39], v[172:175], v[152:167]
    ds_read_b64_tr_b16 v[32:33], v19 offset:24576
    ds_read_b64_tr_b16 v[34:35], v19 offset:26624
    s_waitcnt lgkmcnt(6)
    v_mfma_f32_32x32x16_bf16 v[152:167], v[40:43], v[176:179], v[152:167]
    ds_read_b64_tr_b16 v[36:37], v19 offset:28672
    ds_read_b64_tr_b16 v[38:39], v19 offset:30720
    v_mfma_f32_32x32x16_bf16 v[152:167], v[44:47], v[180:183], v[152:167]
    ds_read_b64_tr_b16 v[40:41], v19 offset:32768
    ds_read_b64_tr_b16 v[42:43], v19 offset:34816
    s_waitcnt lgkmcnt(6)
    v_mfma_f32_32x32x16_bf16 v[152:167], v[48:51], v[184:187], v[152:167]
    ds_read_b64_tr_b16 v[44:45], v19 offset:36864
    ds_read_b64_tr_b16 v[46:47], v19 offset:38912
    v_mfma_f32_32x32x16_bf16 v[152:167], v[52:55], v[188:191], v[152:167]
    s_waitcnt lgkmcnt(4)
    v_mfma_f32_32x32x16_bf16 v[152:167], v[32:35], v[192:195], v[152:167]
    v_mfma_f32_32x32x16_bf16 v[152:167], v[36:39], v[196:199], v[152:167]
    s_waitcnt lgkmcnt(0)
    v_mfma_f32_32x32x16_bf16 v[152:167], v[40:43], v[200:203], v[152:167]
    v_mfma_f32_32x32x16_bf16 v[152:167], v[44:47], v[204:207], v[152:167]
    s_nop 11
    v_mul_f32 v152, v152, v25
    v_mul_f32 v153, v153, v25
    v_mul_f32 v154, v154, v25
    v_mul_f32 v155, v155, v25
    v_mul_f32 v156, v156, v25
    v_mul_f32 v157, v157, v25
    v_mul_f32 v158, v158, v25
    v_mul_f32 v159, v159, v25
    v_mul_f32 v160, v160, v25
    v_mul_f32 v161, v161, v25
    v_mul_f32 v162, v162, v25
    v_mul_f32 v163, v163, v25
    v_mul_f32 v164, v164, v25
    v_mul_f32 v165, v165, v25
    v_mul_f32 v166, v166, v25
    v_mul_f32 v167, v167, v25
    v_cvt_pk_bf16_f32 v152, v152, v153
    v_cvt_pk_bf16_f32 v153, v154, v155
    v_cvt_pk_bf16_f32 v154, v156, v157
    v_cvt_pk_bf16_f32 v155, v158, v159
    v_cvt_pk_bf16_f32 v156, v160, v161
    v_cvt_pk_bf16_f32 v157, v162, v163
    v_cvt_pk_bf16_f32 v158, v164, v165
    v_cvt_pk_bf16_f32 v159, v166, v167
    v_permlane16_swap_b32 v136, v152
    v_permlane16_swap_b32 v137, v153
    v_permlane16_swap_b32 v138, v154
    v_permlane16_swap_b32 v139, v155
    v_permlane16_swap_b32 v140, v156
    v_permlane16_swap_b32 v141, v157
    v_permlane16_swap_b32 v142, v158
    v_permlane16_swap_b32 v143, v159
    buffer_store_dwordx4 v[136:139], v20, s[24:27], s30 offen offset:64 sc1 nt
    buffer_store_dwordx4 v[152:155], v21, s[24:27], s30 offen offset:64 sc1 nt
    buffer_store_dwordx4 v[140:143], v20, s[24:27], s30 offen offset:192 sc1 nt
    buffer_store_dwordx4 v[156:159], v21, s[24:27], s30 offen offset:192 sc1 nt
    s_branch L_fin
L_B:
    s_setprio 2
    s_waitcnt vmcnt(0)
    v_xor_b32 v56, 0x0, v41
    v_xor_b32 v60, 0x20, v41
    v_xor_b32 v64, 0x40, v41
    v_xor_b32 v68, 0x60, v41
    v_xor_b32 v72, 0x80, v41
    v_xor_b32 v76, 0xa0, v41
    v_xor_b32 v80, 0xc0, v41
    v_xor_b32 v84, 0xe0, v41
    ds_read_b128 v[56:59], v56
    ds_read_b128 v[60:63], v60
    ds_read_b128 v[64:67], v64
    ds_read_b128 v[68:71], v68
    ds_read_b128 v[72:75], v72
    ds_read_b128 v[76:79], v76
    ds_read_b128 v[80:83], v80
    ds_read_b128 v[84:87], v84
    s_waitcnt lgkmcnt(0)

    s_barrier
    ds_read_b128 v[32:35], v8 offset:0
    ds_read_b128 v[36:39], v9 offset:0
    ds_read_b128 v[40:43], v10 offset:0
    ds_read_b128 v[44:47], v11 offset:0
    ds_read_b128 v[48:51], v12 offset:0
    s_waitcnt lgkmcnt(3)
    v_mfma_f32_32x32x16_bf16 v[88:103], v[32:35], v[56:59], 0
    ds_read_b128 v[52:55], v13 offset:0
    v_mfma_f32_32x32x16_bf16 v[88:103], v[36:39], v[60:63], v[88:103]
    ds_read_b128 v[32:35], v14 offset:0
    s_waitcnt lgkmcnt(3)
    v_mfma_f32_32x32x16_bf16 v[88:103], v[40:43], v[64:67], v[88:103]
    ds_read_b128 v[36:39], v15 offset:0
    v_mfma_f32_32x32x16_bf16 v[88:103], v[44:47], v[68:71], v[88:103]
    ds_read_b128 v[40:43], v8 offset:8192
    s_waitcnt lgkmcnt(3)
    v_mfma_f32_32x32x16_bf16 v[88:103], v[48:51], v[72:75], v[88:103]
    ds_read_b128 v[44:47], v9 offset:8192
    v_mfma_f32_32x32x16_bf16 v[88:103], v[52:55], v[76:79], v[88:103]
    ds_read_b128 v[48:51], v10 offset:8192
    s_waitcnt lgkmcnt(3)
    v_mfma_f32_32x32x16_bf16 v[88:103], v[32:35], v[80:83], v[88:103]
    ds_read_b128 v[52:55], v11 offset:8192
    v_mfma_f32_32x32x16_bf16 v[88:103], v[36:39], v[84:87], v[88:103]
    ds_read_b128 v[32:35], v12 offset:8192
    s_waitcnt lgkmcnt(3)
    v_mfma_f32_32x32x16_bf16 v[104:119], v[40:43], v[56:59], 0
    ds_read_b128 v[36:39], v13 offset:8192
    v_mfma_f32_32x32x16_bf16 v[104:119], v[44:47], v[60:63], v[104:119]
    ds_read_b128 v[40:43], v14 offset:8192
    s_waitcnt lgkmcnt(3)
    v_mfma_f32_32x32x16_bf16 v[104:119], v[48:51], v[64:67], v[104:119]
    ds_read_b128 v[44:47], v15 offset:8192
    v_mfma_f32_32x32x16_bf16 v[104:119], v[52:55], v[68:71], v[104:119]
    s_barrier
    ds_read_b128 v[48:51], v8 offset:16384
    s_waitcnt lgkmcnt(3)
    v_mfma_f32_32x32x16_bf16 v[104:119], v[32:35], v[72:75], v[104:119]
    ds_read_b128 v[52:55], v9 offset:16384
    v_mfma_f32_32x32x16_bf16 v[104:119], v[36:39], v[76:79], v[104:119]
    ds_read_b128 v[32:35], v10 offset:16384
    s_waitcnt lgkmcnt(3)
    v_mfma_f32_32x32x16_bf16 v[104:119], v[40:43], v[80:83], v[104:119]
    v_max_f32 v22, v88, v89
    v_max3_f32 v22, v22, v90, v91
    v_max3_f32 v22, v22, v92, v93
    v_max3_f32 v22, v22, v94, v95
    v_max3_f32 v22, v22, v96, v97
    v_max3_f32 v22, v22, v98, v99
    v_max3_f32 v22, v22, v100, v101
    v_max3_f32 v22, v22, v102, v103
    ds_read_b128 v[36:39], v11 offset:16384
    v_mfma_f32_32x32x16_bf16 v[104:119], v[44:47], v[84:87], v[104:119]
    ds_read_b128 v[40:43], v12 offset:16384
    s_waitcnt lgkmcnt(3)
    v_mfma_f32_32x32x16_bf16 v[120:135], v[48:51], v[56:59], 0
    ds_read_b128 v[44:47], v13 offset:16384
    v_mfma_f32_32x32x16_bf16 v[120:135], v[52:55], v[60:63], v[120:135]
    ds_read_b128 v[48:51], v14 offset:16384
    s_waitcnt lgkmcnt(3)
    v_mfma_f32_32x32x16_bf16 v[120:135], v[32:35], v[64:67], v[120:135]
    ds_read_b128 v[52:55], v15 offset:16384
    v_mfma_f32_32x32x16_bf16 v[120:135], v[36:39], v[68:71], v[120:135]
    ds_read_b128 v[32:35], v8 offset:24576
    s_waitcnt lgkmcnt(3)
    v_mfma_f32_32x32x16_bf16 v[120:135], v[40:43], v[72:75], v[120:135]
    ds_read_b128 v[36:39], v9 offset:24576
    v_mfma_f32_32x32x16_bf16 v[120:135], v[44:47], v[76:79], v[120:135]
    ds_read_b128 v[40:43], v10 offset:24576
    s_waitcnt lgkmcnt(3)
    v_mfma_f32_32x32x16_bf16 v[120:135], v[48:51], v[80:83], v[120:135]
    v_max3_f32 v22, v22, v104, v105
    v_max3_f32 v22, v22, v106, v107
    v_max3_f32 v22, v22, v108, v109
    v_max3_f32 v22, v22, v110, v111
    v_max3_f32 v22, v22, v112, v113
    v_max3_f32 v22, v22, v114, v115
    v_max3_f32 v22, v22, v116, v117
    v_max3_f32 v22, v22, v118, v119
    ds_read_b128 v[44:47], v11 offset:24576
    v_mfma_f32_32x32x16_bf16 v[120:135], v[52:55], v[84:87], v[120:135]
    ds_read_b128 v[48:51], v12 offset:24576
    s_waitcnt lgkmcnt(3)
    v_mfma_f32_32x32x16_bf16 v[136:151], v[32:35], v[56:59], 0
    ds_read_b128 v[52:55], v13 offset:24576
    v_mfma_f32_32x32x16_bf16 v[136:151], v[36:39], v[60:63], v[136:151]
    ds_read_b128 v[32:35], v14 offset:24576
    s_waitcnt lgkmcnt(3)
    v_mfma_f32_32x32x16_bf16 v[136:151], v[40:43], v[64:67], v[136:151]
    ds_read_b128 v[36:39], v15 offset:24576
    v_mfma_f32_32x32x16_bf16 v[136:151], v[44:47], v[68:71], v[136:151]
    s_barrier
    ds_read_b128 v[40:43], v8 offset:32768
    s_waitcnt lgkmcnt(3)
    v_mfma_f32_32x32x16_bf16 v[136:151], v[48:51], v[72:75], v[136:151]
    ds_read_b128 v[44:47], v9 offset:32768
    v_mfma_f32_32x32x16_bf16 v[136:151], v[52:55], v[76:79], v[136:151]
    ds_read_b128 v[48:51], v10 offset:32768
    s_waitcnt lgkmcnt(3)
    v_mfma_f32_32x32x16_bf16 v[136:151], v[32:35], v[80:83], v[136:151]
    v_max3_f32 v22, v22, v120, v121
    v_max3_f32 v22, v22, v122, v123
    v_max3_f32 v22, v22, v124, v125
    v_max3_f32 v22, v22, v126, v127
    v_max3_f32 v22, v22, v128, v129
    v_max3_f32 v22, v22, v130, v131
    v_max3_f32 v22, v22, v132, v133
    v_max3_f32 v22, v22, v134, v135
    ds_read_b128 v[52:55], v11 offset:32768
    v_mfma_f32_32x32x16_bf16 v[136:151], v[36:39], v[84:87], v[136:151]
    ds_read_b128 v[32:35], v12 offset:32768
    s_waitcnt lgkmcnt(3)
    v_mfma_f32_32x32x16_bf16 v[152:167], v[40:43], v[56:59], 0
    ds_read_b128 v[36:39], v13 offset:32768
    v_mfma_f32_32x32x16_bf16 v[152:167], v[44:47], v[60:63], v[152:167]
    ds_read_b128 v[40:43], v14 offset:32768
    s_waitcnt lgkmcnt(3)
    v_mfma_f32_32x32x16_bf16 v[152:167], v[48:51], v[64:67], v[152:167]
    ds_read_b128 v[44:47], v15 offset:32768
    v_mfma_f32_32x32x16_bf16 v[152:167], v[52:55], v[68:71], v[152:167]
    v_add_u32 v8, 0xa000, v8
    v_add_u32 v9, 0xa000, v9
    v_add_u32 v10, 0xa000, v10
    v_add_u32 v11, 0xa000, v11
    v_add_u32 v12, 0xa000, v12
    v_add_u32 v13, 0xa000, v13
    v_add_u32 v14, 0xa000, v14
    v_add_u32 v15, 0xa000, v15
    ds_read_b128 v[48:51], v8 offset:0
    s_waitcnt lgkmcnt(3)
    v_mfma_f32_32x32x16_bf16 v[152:167], v[32:35], v[72:75], v[152:167]
    v_max3_f32 v22, v22, v136, v137
    v_max3_f32 v22, v22, v138, v139
    v_max3_f32 v22, v22, v140, v141
    v_max3_f32 v22, v22, v142, v143
    v_max3_f32 v22, v22, v144, v145
    v_max3_f32 v22, v22, v146, v147
    v_max3_f32 v22, v22, v148, v149
    v_max3_f32 v22, v22, v150, v151
    ds_read_b128 v[52:55], v9 offset:0
    v_mfma_f32_32x32x16_bf16 v[152:167], v[36:39], v[76:79], v[152:167]
    ds_read_b128 v[32:35], v10 offset:0
    s_waitcnt lgkmcnt(3)
    v_mfma_f32_32x32x16_bf16 v[152:167], v[40:43], v[80:83], v[152:167]
    ds_read_b128 v[36:39], v11 offset:0
    v_mfma_f32_32x32x16_bf16 v[152:167], v[44:47], v[84:87], v[152:167]
    ds_read_b128 v[40:43], v12 offset:0
    s_waitcnt lgkmcnt(3)
    v_mfma_f32_32x32x16_bf16 v[168:183], v[48:51], v[56:59], 0
    ds_read_b128 v[44:47], v13 offset:0
    v_mfma_f32_32x32x16_bf16 v[168:183], v[52:55], v[60:63], v[168:183]
    ds_read_b128 v[48:51], v14 offset:0
    s_waitcnt lgkmcnt(3)
    v_mfma_f32_32x32x16_bf16 v[168:183], v[32:35], v[64:67], v[168:183]
    ds_read_b128 v[52:55], v15 offset:0
    v_mfma_f32_32x32x16_bf16 v[168:183], v[36:39], v[68:71], v[168:183]
    s_barrier
    ds_read_b128 v[32:35], v8 offset:8192
    s_waitcnt lgkmcnt(3)
    v_mfma_f32_32x32x16_bf16 v[168:183], v[40:43], v[72:75], v[168:183]
    ds_read_b128 v[36:39], v9 offset:8192
    v_mfma_f32_32x32x16_bf16 v[168:183], v[44:47], v[76:79], v[168:183]
    ds_read_b128 v[40:43], v10 offset:8192
    s_waitcnt lgkmcnt(3)
    v_mfma_f32_32x32x16_bf16 v[168:183], v[48:51], v[80:83], v[168:183]
    v_max3_f32 v22, v22, v152, v153
    v_max3_f32 v22, v22, v154, v155
    v_max3_f32 v22, v22, v156, v157
    v_max3_f32 v22, v22, v158, v159
    v_max3_f32 v22, v22, v160, v161
    v_max3_f32 v22, v22, v162, v163
    v_max3_f32 v22, v22, v164, v165
    v_max3_f32 v22, v22, v166, v167
    ds_read_b128 v[44:47], v11 offset:8192
    v_mfma_f32_32x32x16_bf16 v[168:183], v[52:55], v[84:87], v[168:183]
    ds_read_b128 v[48:51], v12 offset:8192
    s_waitcnt lgkmcnt(3)
    v_mfma_f32_32x32x16_bf16 v[184:199], v[32:35], v[56:59], 0
    ds_read_b128 v[52:55], v13 offset:8192
    v_mfma_f32_32x32x16_bf16 v[184:199], v[36:39], v[60:63], v[184:199]
    ds_read_b128 v[32:35], v14 offset:8192
    s_waitcnt lgkmcnt(3)
    v_mfma_f32_32x32x16_bf16 v[184:199], v[40:43], v[64:67], v[184:199]
    ds_read_b128 v[36:39], v15 offset:8192
    v_mfma_f32_32x32x16_bf16 v[184:199], v[44:47], v[68:71], v[184:199]
    ds_read_b128 v[40:43], v8 offset:16384
    s_waitcnt lgkmcnt(3)
    v_mfma_f32_32x32x16_bf16 v[184:199], v[48:51], v[72:75], v[184:199]
    ds_read_b128 v[44:47], v9 offset:16384
    v_mfma_f32_32x32x16_bf16 v[184:199], v[52:55], v[76:79], v[184:199]
    ds_read_b128 v[48:51], v10 offset:16384
    s_waitcnt lgkmcnt(3)
    v_mfma_f32_32x32x16_bf16 v[184:199], v[32:35], v[80:83], v[184:199]
    v_max3_f32 v23, v22, v168, v169
    v_max3_f32 v23, v23, v170, v171
    v_max3_f32 v23, v23, v172, v173
    v_max3_f32 v23, v23, v174, v175
    v_max3_f32 v23, v23, v176, v177
    v_max3_f32 v23, v23, v178, v179
    v_max3_f32 v23, v23, v180, v181
    v_max3_f32 v23, v23, v182, v183
    ds_read_b128 v[52:55], v11 offset:16384
    v_mfma_f32_32x32x16_bf16 v[184:199], v[36:39], v[84:87], v[184:199]
    ds_read_b128 v[32:35], v12 offset:16384
    s_waitcnt lgkmcnt(3)
    v_mfma_f32_32x32x16_bf16 v[200:215], v[40:43], v[56:59], 0
    ds_read_b128 v[36:39], v13 offset:16384
    v_mfma_f32_32x32x16_bf16 v[200:215], v[44:47], v[60:63], v[200:215]
    ds_read_b128 v[40:43], v14 offset:16384
    s_waitcnt lgkmcnt(3)
    v_mfma_f32_32x32x16_bf16 v[200:215], v[48:51], v[64:67], v[200:215]
    ds_read_b128 v[44:47], v15 offset:16384
    v_mfma_f32_32x32x16_bf16 v[200:215], v[52:55], v[68:71], v[200:215]
    s_barrier
    ds_read_b128 v[48:51], v8 offset:24576
    s_waitcnt lgkmcnt(3)
    v_mfma_f32_32x32x16_bf16 v[200:215], v[32:35], v[72:75], v[200:215]
    ds_read_b128 v[52:55], v9 offset:24576
    v_mfma_f32_32x32x16_bf16 v[200:215], v[36:39], v[76:79], v[200:215]
    ds_read_b128 v[32:35], v10 offset:24576
    s_waitcnt lgkmcnt(3)
    v_mfma_f32_32x32x16_bf16 v[200:215], v[40:43], v[80:83], v[200:215]
    v_max3_f32 v23, v23, v184, v185
    v_max3_f32 v23, v23, v186, v187
    v_max3_f32 v23, v23, v188, v189
    v_max3_f32 v23, v23, v190, v191
    v_max3_f32 v23, v23, v192, v193
    v_max3_f32 v23, v23, v194, v195
    v_max3_f32 v23, v23, v196, v197
    v_max3_f32 v23, v23, v198, v199
    ds_read_b128 v[36:39], v11 offset:24576
    v_mfma_f32_32x32x16_bf16 v[200:215], v[44:47], v[84:87], v[200:215]
    ds_read_b128 v[40:43], v12 offset:24576
    s_waitcnt lgkmcnt(3)
    v_mfma_f32_32x32x16_bf16 v[216:231], v[48:51], v[56:59], 0
    ds_read_b128 v[44:47], v13 offset:24576
    v_mfma_f32_32x32x16_bf16 v[216:231], v[52:55], v[60:63], v[216:231]
    ds_read_b128 v[48:51], v14 offset:24576
    s_waitcnt lgkmcnt(3)
    v_mfma_f32_32x32x16_bf16 v[216:231], v[32:35], v[64:67], v[216:231]
    ds_read_b128 v[52:55], v15 offset:24576
    v_mfma_f32_32x32x16_bf16 v[216:231], v[36:39], v[68:71], v[216:231]
    ds_read_b128 v[32:35], v8 offset:32768
    s_waitcnt lgkmcnt(3)
    v_mfma_f32_32x32x16_bf16 v[216:231], v[40:43], v[72:75], v[216:231]
    ds_read_b128 v[36:39], v9 offset:32768
    v_mfma_f32_32x32x16_bf16 v[216:231], v[44:47], v[76:79], v[216:231]
    ds_read_b128 v[40:43], v10 offset:32768
    s_waitcnt lgkmcnt(3)
    v_mfma_f32_32x32x16_bf16 v[216:231], v[48:51], v[80:83], v[216:231]
    v_max3_f32 v23, v23, v200, v201
    v_max3_f32 v23, v23, v202, v203
    v_max3_f32 v23, v23, v204, v205
    v_max3_f32 v23, v23, v206, v207
    v_max3_f32 v23, v23, v208, v209
    v_max3_f32 v23, v23, v210, v211
    v_max3_f32 v23, v23, v212, v213
    v_max3_f32 v23, v23, v214, v215
    ds_read_b128 v[44:47], v11 offset:32768
    v_mfma_f32_32x32x16_bf16 v[216:231], v[52:55], v[84:87], v[216:231]
    ds_read_b128 v[48:51], v12 offset:32768
    s_waitcnt lgkmcnt(3)
    v_mfma_f32_32x32x16_bf16 v[232:247], v[32:35], v[56:59], 0
    ds_read_b128 v[52:55], v13 offset:32768
    v_mfma_f32_32x32x16_bf16 v[232:247], v[36:39], v[60:63], v[232:247]
    ds_read_b128 v[32:35], v14 offset:32768
    s_waitcnt lgkmcnt(3)
    v_mfma_f32_32x32x16_bf16 v[232:247], v[40:43], v[64:67], v[232:247]
    ds_read_b128 v[36:39], v15 offset:32768
    v_mfma_f32_32x32x16_bf16 v[232:247], v[44:47], v[68:71], v[232:247]
    s_waitcnt lgkmcnt(2)
    v_mfma_f32_32x32x16_bf16 v[232:247], v[48:51], v[72:75], v[232:247]
    v_mfma_f32_32x32x16_bf16 v[232:247], v[52:55], v[76:79], v[232:247]
    s_waitcnt lgkmcnt(0)
    v_mfma_f32_32x32x16_bf16 v[232:247], v[32:35], v[80:83], v[232:247]
    v_mfma_f32_32x32x16_bf16 v[232:247], v[36:39], v[84:87], v[232:247]
    v_max3_f32 v23, v23, v216, v217
    v_max3_f32 v23, v23, v218, v219
    v_max3_f32 v23, v23, v220, v221
    v_max3_f32 v23, v23, v222, v223
    v_max3_f32 v23, v23, v224, v225
    v_max3_f32 v23, v23, v226, v227
    v_max3_f32 v23, v23, v228, v229
    v_max3_f32 v23, v23, v230, v231
    s_nop 3
    v_max3_f32 v23, v23, v232, v233
    v_max3_f32 v23, v23, v234, v235
    v_max3_f32 v23, v23, v236, v237
    v_max3_f32 v23, v23, v238, v239
    v_max3_f32 v23, v23, v240, v241
    v_max3_f32 v23, v23, v242, v243
    v_max3_f32 v23, v23, v244, v245
    v_max3_f32 v23, v23, v246, v247
    v_mov_b32 v3, v23
    s_nop 1
    v_permlane32_swap_b32 v23, v3
    v_max_f32 v23, v23, v3
    v_mov_b32 v8, v26
    v_mov_b32 v9, v26
    v_mov_b32 v10, v26
    v_mov_b32 v11, v26
    s_setprio 0
    v_mul_f32 v24, s29, v23
    v_fmamk_f32 v88, v88, 0x3e0293ee, v24
    v_fmamk_f32 v89, v89, 0x3e0293ee, v24
    v_fmamk_f32 v90, v90, 0x3e0293ee, v24
    v_fmamk_f32 v91, v91, 0x3e0293ee, v24
    v_fmamk_f32 v92, v92, 0x3e0293ee, v24
    v_fmamk_f32 v93, v93, 0x3e0293ee, v24
    v_fmamk_f32 v94, v94, 0x3e0293ee, v24
    v_fmamk_f32 v95, v95, 0x3e0293ee, v24
    v_exp_f32 v88, v88
    v_exp_f32 v89, v89
    v_exp_f32 v90, v90
    v_exp_f32 v91, v91
    v_exp_f32 v92, v92
    v_exp_f32 v93, v93
    v_exp_f32 v94, v94
    v_exp_f32 v95, v95
    v_cvt_pk_bf16_f32 v88, v88, v89
    v_cvt_pk_bf16_f32 v89, v90, v91
    v_cvt_pk_bf16_f32 v90, v92, v93
    v_cvt_pk_bf16_f32 v91, v94, v95
    v_fmamk_f32 v96, v96, 0x3e0293ee, v24
    v_fmamk_f32 v97, v97, 0x3e0293ee, v24
    v_fmamk_f32 v98, v98, 0x3e0293ee, v24
    v_fmamk_f32 v99, v99, 0x3e0293ee, v24
    v_fmamk_f32 v100, v100, 0x3e0293ee, v24
    v_fmamk_f32 v101, v101, 0x3e0293ee, v24
    v_fmamk_f32 v102, v102, 0x3e0293ee, v24
    v_fmamk_f32 v103, v103, 0x3e0293ee, v24
    v_exp_f32 v96, v96
    v_exp_f32 v97, v97
    v_exp_f32 v98, v98
    v_exp_f32 v99, v99
    v_exp_f32 v100, v100
    v_exp_f32 v101, v101
    v_exp_f32 v102, v102
    v_exp_f32 v103, v103
    v_cvt_pk_bf16_f32 v92, v96, v97
    v_cvt_pk_bf16_f32 v93, v98, v99
    v_cvt_pk_bf16_f32 v94, v100, v101
    v_cvt_pk_bf16_f32 v95, v102, v103
    v_fmamk_f32 v104, v104, 0x3e0293ee, v24
    v_fmamk_f32 v105, v105, 0x3e0293ee, v24
    v_fmamk_f32 v106, v106, 0x3e0293ee, v24
    v_fmamk_f32 v107, v107, 0x3e0293ee, v24
    v_fmamk_f32 v108, v108, 0x3e0293ee, v24
    v_fmamk_f32 v109, v109, 0x3e0293ee, v24
    v_fmamk_f32 v110, v110, 0x3e0293ee, v24
    v_fmamk_f32 v111, v111, 0x3e0293ee, v24
    v_exp_f32 v104, v104
    v_exp_f32 v105, v105
    v_exp_f32 v106, v106
    v_exp_f32 v107, v107
    v_exp_f32 v108, v108
    v_exp_f32 v109, v109
    v_exp_f32 v110, v110
    v_exp_f32 v111, v111
    v_cvt_pk_bf16_f32 v96, v104, v105
    v_cvt_pk_bf16_f32 v97, v106, v107
    v_cvt_pk_bf16_f32 v98, v108, v109
    v_cvt_pk_bf16_f32 v99, v110, v111
    v_fmamk_f32 v112, v112, 0x3e0293ee, v24
    v_fmamk_f32 v113, v113, 0x3e0293ee, v24
    v_fmamk_f32 v114, v114, 0x3e0293ee, v24
    v_fmamk_f32 v115, v115, 0x3e0293ee, v24
    v_fmamk_f32 v116, v116, 0x3e0293ee, v24
    v_fmamk_f32 v117, v117, 0x3e0293ee, v24
    v_fmamk_f32 v118, v118, 0x3e0293ee, v24
    v_fmamk_f32 v119, v119, 0x3e0293ee, v24
    v_exp_f32 v112, v112
    v_exp_f32 v113, v113
    v_exp_f32 v114, v114
    v_exp_f32 v115, v115
    v_exp_f32 v116, v116
    v_exp_f32 v117, v117
    v_exp_f32 v118, v118
    v_exp_f32 v119, v119
    v_cvt_pk_bf16_f32 v100, v112, v113
    v_cvt_pk_bf16_f32 v101, v114, v115
    v_cvt_pk_bf16_f32 v102, v116, v117
    v_cvt_pk_bf16_f32 v103, v118, v119
    v_fmamk_f32 v120, v120, 0x3e0293ee, v24
    v_fmamk_f32 v121, v121, 0x3e0293ee, v24
    v_fmamk_f32 v122, v122, 0x3e0293ee, v24
    v_fmamk_f32 v123, v123, 0x3e0293ee, v24
    v_fmamk_f32 v124, v124, 0x3e0293ee, v24
    v_fmamk_f32 v125, v125, 0x3e0293ee, v24
    v_fmamk_f32 v126, v126, 0x3e0293ee, v24
    v_fmamk_f32 v127, v127, 0x3e0293ee, v24
    v_exp_f32 v120, v120
    v_exp_f32 v121, v121
    v_exp_f32 v122, v122
    v_exp_f32 v123, v123
    v_exp_f32 v124, v124
    v_exp_f32 v125, v125
    v_exp_f32 v126, v126
    v_exp_f32 v127, v127
    v_cvt_pk_bf16_f32 v104, v120, v121
    v_cvt_pk_bf16_f32 v105, v122, v123
    v_cvt_pk_bf16_f32 v106, v124, v125
    v_cvt_pk_bf16_f32 v107, v126, v127
    v_fmamk_f32 v128, v128, 0x3e0293ee, v24
    v_fmamk_f32 v129, v129, 0x3e0293ee, v24
    v_fmamk_f32 v130, v130, 0x3e0293ee, v24
    v_fmamk_f32 v131, v131, 0x3e0293ee, v24
    v_fmamk_f32 v132, v132, 0x3e0293ee, v24
    v_fmamk_f32 v133, v133, 0x3e0293ee, v24
    v_fmamk_f32 v134, v134, 0x3e0293ee, v24
    v_fmamk_f32 v135, v135, 0x3e0293ee, v24
    v_exp_f32 v128, v128
    v_exp_f32 v129, v129
    v_exp_f32 v130, v130
    v_exp_f32 v131, v131
    v_exp_f32 v132, v132
    v_exp_f32 v133, v133
    v_exp_f32 v134, v134
    v_exp_f32 v135, v135
    v_cvt_pk_bf16_f32 v108, v128, v129
    v_cvt_pk_bf16_f32 v109, v130, v131
    v_cvt_pk_bf16_f32 v110, v132, v133
    v_cvt_pk_bf16_f32 v111, v134, v135
    v_fmamk_f32 v136, v136, 0x3e0293ee, v24
    v_fmamk_f32 v137, v137, 0x3e0293ee, v24
    v_fmamk_f32 v138, v138, 0x3e0293ee, v24
    v_fmamk_f32 v139, v139, 0x3e0293ee, v24
    v_fmamk_f32 v140, v140, 0x3e0293ee, v24
    v_fmamk_f32 v141, v141, 0x3e0293ee, v24
    v_fmamk_f32 v142, v142, 0x3e0293ee, v24
    v_fmamk_f32 v143, v143, 0x3e0293ee, v24
    v_exp_f32 v136, v136
    v_exp_f32 v137, v137
    v_exp_f32 v138, v138
    v_exp_f32 v139, v139
    v_exp_f32 v140, v140
    v_exp_f32 v141, v141
    v_exp_f32 v142, v142
    v_exp_f32 v143, v143
    v_cvt_pk_bf16_f32 v112, v136, v137
    v_cvt_pk_bf16_f32 v113, v138, v139
    v_cvt_pk_bf16_f32 v114, v140, v141
    v_cvt_pk_bf16_f32 v115, v142, v143
    v_fmamk_f32 v144, v144, 0x3e0293ee, v24
    v_fmamk_f32 v145, v145, 0x3e0293ee, v24
    v_fmamk_f32 v146, v146, 0x3e0293ee, v24
    v_fmamk_f32 v147, v147, 0x3e0293ee, v24
    v_fmamk_f32 v148, v148, 0x3e0293ee, v24
    v_fmamk_f32 v149, v149, 0x3e0293ee, v24
    v_fmamk_f32 v150, v150, 0x3e0293ee, v24
    v_fmamk_f32 v151, v151, 0x3e0293ee, v24
    v_exp_f32 v144, v144
    v_exp_f32 v145, v145
    v_exp_f32 v146, v146
    v_exp_f32 v147, v147
    v_exp_f32 v148, v148
    v_exp_f32 v149, v149
    v_exp_f32 v150, v150
    v_exp_f32 v151, v151
    v_cvt_pk_bf16_f32 v116, v144, v145
    v_cvt_pk_bf16_f32 v117, v146, v147
    v_cvt_pk_bf16_f32 v118, v148, v149
    v_cvt_pk_bf16_f32 v119, v150, v151
    v_fmamk_f32 v152, v152, 0x3e0293ee, v24
    v_fmamk_f32 v153, v153, 0x3e0293ee, v24
    v_fmamk_f32 v154, v154, 0x3e0293ee, v24
    v_fmamk_f32 v155, v155, 0x3e0293ee, v24
    v_fmamk_f32 v156, v156, 0x3e0293ee, v24
    v_fmamk_f32 v157, v157, 0x3e0293ee, v24
    v_fmamk_f32 v158, v158, 0x3e0293ee, v24
    v_fmamk_f32 v159, v159, 0x3e0293ee, v24
    v_exp_f32 v152, v152
    v_exp_f32 v153, v153
    v_exp_f32 v154, v154
    v_exp_f32 v155, v155
    v_exp_f32 v156, v156
    v_exp_f32 v157, v157
    v_exp_f32 v158, v158
    v_exp_f32 v159, v159
    v_cvt_pk_bf16_f32 v120, v152, v153
    v_cvt_pk_bf16_f32 v121, v154, v155
    v_cvt_pk_bf16_f32 v122, v156, v157
    v_cvt_pk_bf16_f32 v123, v158, v159
    v_fmamk_f32 v160, v160, 0x3e0293ee, v24
    v_fmamk_f32 v161, v161, 0x3e0293ee, v24
    v_fmamk_f32 v162, v162, 0x3e0293ee, v24
    v_fmamk_f32 v163, v163, 0x3e0293ee, v24
    v_fmamk_f32 v164, v164, 0x3e0293ee, v24
    v_fmamk_f32 v165, v165, 0x3e0293ee, v24
    v_fmamk_f32 v166, v166, 0x3e0293ee, v24
    v_fmamk_f32 v167, v167, 0x3e0293ee, v24
    v_exp_f32 v160, v160
    v_exp_f32 v161, v161
    v_exp_f32 v162, v162
    v_exp_f32 v163, v163
    v_exp_f32 v164, v164
    v_exp_f32 v165, v165
    v_exp_f32 v166, v166
    v_exp_f32 v167, v167
    v_cvt_pk_bf16_f32 v124, v160, v161
    v_cvt_pk_bf16_f32 v125, v162, v163
    v_cvt_pk_bf16_f32 v126, v164, v165
    v_cvt_pk_bf16_f32 v127, v166, v167
    v_fmamk_f32 v168, v168, 0x3e0293ee, v24
    v_fmamk_f32 v169, v169, 0x3e0293ee, v24
    v_fmamk_f32 v170, v170, 0x3e0293ee, v24
    v_fmamk_f32 v171, v171, 0x3e0293ee, v24
    v_fmamk_f32 v172, v172, 0x3e0293ee, v24
    v_fmamk_f32 v173, v173, 0x3e0293ee, v24
    v_fmamk_f32 v174, v174, 0x3e0293ee, v24
    v_fmamk_f32 v175, v175, 0x3e0293ee, v24
    v_exp_f32 v168, v168
    v_exp_f32 v169, v169
    v_exp_f32 v170, v170
    v_exp_f32 v171, v171
    v_exp_f32 v172, v172
    v_exp_f32 v173, v173
    v_exp_f32 v174, v174
    v_exp_f32 v175, v175
    v_cvt_pk_bf16_f32 v168, v168, v169
    v_cvt_pk_bf16_f32 v169, v170, v171
    v_cvt_pk_bf16_f32 v170, v172, v173
    v_cvt_pk_bf16_f32 v171, v174, v175
    v_fmamk_f32 v176, v176, 0x3e0293ee, v24
    v_fmamk_f32 v177, v177, 0x3e0293ee, v24
    v_fmamk_f32 v178, v178, 0x3e0293ee, v24
    v_fmamk_f32 v179, v179, 0x3e0293ee, v24
    v_fmamk_f32 v180, v180, 0x3e0293ee, v24
    v_fmamk_f32 v181, v181, 0x3e0293ee, v24
    v_fmamk_f32 v182, v182, 0x3e0293ee, v24
    v_fmamk_f32 v183, v183, 0x3e0293ee, v24
    v_exp_f32 v176, v176
    v_exp_f32 v177, v177
    v_exp_f32 v178, v178
    v_exp_f32 v179, v179
    v_exp_f32 v180, v180
    v_exp_f32 v181, v181
    v_exp_f32 v182, v182
    v_exp_f32 v183, v183
    v_cvt_pk_bf16_f32 v172, v176, v177
    v_cvt_pk_bf16_f32 v173, v178, v179
    v_cvt_pk_bf16_f32 v174, v180, v181
    v_cvt_pk_bf16_f32 v175, v182, v183
    v_fmamk_f32 v184, v184, 0x3e0293ee, v24
    v_fmamk_f32 v185, v185, 0x3e0293ee, v24
    v_fmamk_f32 v186, v186, 0x3e0293ee, v24
    v_fmamk_f32 v187, v187, 0x3e0293ee, v24
    v_fmamk_f32 v188, v188, 0x3e0293ee, v24
    v_fmamk_f32 v189, v189, 0x3e0293ee, v24
    v_fmamk_f32 v190, v190, 0x3e0293ee, v24
    v_fmamk_f32 v191, v191, 0x3e0293ee, v24
    v_exp_f32 v184, v184
    v_exp_f32 v185, v185
    v_exp_f32 v186, v186
    v_exp_f32 v187, v187
    v_exp_f32 v188, v188
    v_exp_f32 v189, v189
    v_exp_f32 v190, v190
    v_exp_f32 v191, v191
    v_cvt_pk_bf16_f32 v176, v184, v185
    v_cvt_pk_bf16_f32 v177, v186, v187
    v_cvt_pk_bf16_f32 v178, v188, v189
    v_cvt_pk_bf16_f32 v179, v190, v191
    v_fmamk_f32 v192, v192, 0x3e0293ee, v24
    v_fmamk_f32 v193, v193, 0x3e0293ee, v24
    v_fmamk_f32 v194, v194, 0x3e0293ee, v24
    v_fmamk_f32 v195, v195, 0x3e0293ee, v24
    v_fmamk_f32 v196, v196, 0x3e0293ee, v24
    v_fmamk_f32 v197, v197, 0x3e0293ee, v24
    v_fmamk_f32 v198, v198, 0x3e0293ee, v24
    v_fmamk_f32 v199, v199, 0x3e0293ee, v24
    v_exp_f32 v192, v192
    v_exp_f32 v193, v193
    v_exp_f32 v194, v194
    v_exp_f32 v195, v195
    v_exp_f32 v196, v196
    v_exp_f32 v197, v197
    v_exp_f32 v198, v198
    v_exp_f32 v199, v199
    v_cvt_pk_bf16_f32 v180, v192, v193
    v_cvt_pk_bf16_f32 v181, v194, v195
    v_cvt_pk_bf16_f32 v182, v196, v197
    v_cvt_pk_bf16_f32 v183, v198, v199
    v_fmamk_f32 v200, v200, 0x3e0293ee, v24
    v_fmamk_f32 v201, v201, 0x3e0293ee, v24
    v_fmamk_f32 v202, v202, 0x3e0293ee, v24
    v_fmamk_f32 v203, v203, 0x3e0293ee, v24
    v_fmamk_f32 v204, v204, 0x3e0293ee, v24
    v_fmamk_f32 v205, v205, 0x3e0293ee, v24
    v_fmamk_f32 v206, v206, 0x3e0293ee, v24
    v_fmamk_f32 v207, v207, 0x3e0293ee, v24
    v_exp_f32 v200, v200
    v_exp_f32 v201, v201
    v_exp_f32 v202, v202
    v_exp_f32 v203, v203
    v_exp_f32 v204, v204
    v_exp_f32 v205, v205
    v_exp_f32 v206, v206
    v_exp_f32 v207, v207
    v_cvt_pk_bf16_f32 v184, v200, v201
    v_cvt_pk_bf16_f32 v185, v202, v203
    v_cvt_pk_bf16_f32 v186, v204, v205
    v_cvt_pk_bf16_f32 v187, v206, v207
    v_fmamk_f32 v208, v208, 0x3e0293ee, v24
    v_fmamk_f32 v209, v209, 0x3e0293ee, v24
    v_fmamk_f32 v210, v210, 0x3e0293ee, v24
    v_fmamk_f32 v211, v211, 0x3e0293ee, v24
    v_fmamk_f32 v212, v212, 0x3e0293ee, v24
    v_fmamk_f32 v213, v213, 0x3e0293ee, v24
    v_fmamk_f32 v214, v214, 0x3e0293ee, v24
    v_fmamk_f32 v215, v215, 0x3e0293ee, v24
    v_exp_f32 v208, v208
    v_exp_f32 v209, v209
    v_exp_f32 v210, v210
    v_exp_f32 v211, v211
    v_exp_f32 v212, v212
    v_exp_f32 v213, v213
    v_exp_f32 v214, v214
    v_exp_f32 v215, v215
    v_cvt_pk_bf16_f32 v188, v208, v209
    v_cvt_pk_bf16_f32 v189, v210, v211
    v_cvt_pk_bf16_f32 v190, v212, v213
    v_cvt_pk_bf16_f32 v191, v214, v215
    v_fmamk_f32 v216, v216, 0x3e0293ee, v24
    v_fmamk_f32 v217, v217, 0x3e0293ee, v24
    v_fmamk_f32 v218, v218, 0x3e0293ee, v24
    v_fmamk_f32 v219, v219, 0x3e0293ee, v24
    v_fmamk_f32 v220, v220, 0x3e0293ee, v24
    v_fmamk_f32 v221, v221, 0x3e0293ee, v24
    v_fmamk_f32 v222, v222, 0x3e0293ee, v24
    v_fmamk_f32 v223, v223, 0x3e0293ee, v24
    v_exp_f32 v216, v216
    v_exp_f32 v217, v217
    v_exp_f32 v218, v218
    v_exp_f32 v219, v219
    v_exp_f32 v220, v220
    v_exp_f32 v221, v221
    v_exp_f32 v222, v222
    v_exp_f32 v223, v223
    v_cvt_pk_bf16_f32 v192, v216, v217
    v_cvt_pk_bf16_f32 v193, v218, v219
    v_cvt_pk_bf16_f32 v194, v220, v221
    v_cvt_pk_bf16_f32 v195, v222, v223
    v_fmamk_f32 v224, v224, 0x3e0293ee, v24
    v_fmamk_f32 v225, v225, 0x3e0293ee, v24
    v_fmamk_f32 v226, v226, 0x3e0293ee, v24
    v_fmamk_f32 v227, v227, 0x3e0293ee, v24
    v_fmamk_f32 v228, v228, 0x3e0293ee, v24
    v_fmamk_f32 v229, v229, 0x3e0293ee, v24
    v_fmamk_f32 v230, v230, 0x3e0293ee, v24
    v_fmamk_f32 v231, v231, 0x3e0293ee, v24
    v_exp_f32 v224, v224
    v_exp_f32 v225, v225
    v_exp_f32 v226, v226
    v_exp_f32 v227, v227
    v_exp_f32 v228, v228
    v_exp_f32 v229, v229
    v_exp_f32 v230, v230
    v_exp_f32 v231, v231
    v_cvt_pk_bf16_f32 v196, v224, v225
    v_cvt_pk_bf16_f32 v197, v226, v227
    v_cvt_pk_bf16_f32 v198, v228, v229
    v_cvt_pk_bf16_f32 v199, v230, v231
    v_fmamk_f32 v232, v232, 0x3e0293ee, v24
    v_fmamk_f32 v233, v233, 0x3e0293ee, v24
    v_fmamk_f32 v234, v234, 0x3e0293ee, v24
    v_fmamk_f32 v235, v235, 0x3e0293ee, v24
    v_fmamk_f32 v236, v236, 0x3e0293ee, v24
    v_fmamk_f32 v237, v237, 0x3e0293ee, v24
    v_fmamk_f32 v238, v238, 0x3e0293ee, v24
    v_fmamk_f32 v239, v239, 0x3e0293ee, v24
    v_exp_f32 v232, v232
    v_exp_f32 v233, v233
    v_exp_f32 v234, v234
    v_exp_f32 v235, v235
    v_exp_f32 v236, v236
    v_exp_f32 v237, v237
    v_exp_f32 v238, v238
    v_exp_f32 v239, v239
    v_cvt_pk_bf16_f32 v200, v232, v233
    v_cvt_pk_bf16_f32 v201, v234, v235
    v_cvt_pk_bf16_f32 v202, v236, v237
    v_cvt_pk_bf16_f32 v203, v238, v239
    v_fmamk_f32 v240, v240, 0x3e0293ee, v24
    v_fmamk_f32 v241, v241, 0x3e0293ee, v24
    v_fmamk_f32 v242, v242, 0x3e0293ee, v24
    v_fmamk_f32 v243, v243, 0x3e0293ee, v24
    v_fmamk_f32 v244, v244, 0x3e0293ee, v24
    v_fmamk_f32 v245, v245, 0x3e0293ee, v24
    v_fmamk_f32 v246, v246, 0x3e0293ee, v24
    v_fmamk_f32 v247, v247, 0x3e0293ee, v24
    v_exp_f32 v240, v240
    v_exp_f32 v241, v241
    v_exp_f32 v242, v242
    v_exp_f32 v243, v243
    v_exp_f32 v244, v244
    v_exp_f32 v245, v245
    v_exp_f32 v246, v246
    v_exp_f32 v247, v247
    v_cvt_pk_bf16_f32 v204, v240, v241
    v_cvt_pk_bf16_f32 v205, v242, v243
    v_cvt_pk_bf16_f32 v206, v244, v245
    v_cvt_pk_bf16_f32 v207, v246, v247
    buffer_load_dwordx4 v[248:251], v2, s[12:15], s30 offen offset:0
    buffer_load_dwordx4 v[252:255], v2, s[12:15], s30 offen offset:64
    buffer_load_dwordx4 v[4:7], v2, s[12:15], s30 offen offset:128
    buffer_load_dwordx4 v[28:31], v2, s[12:15], s30 offen offset:192
    s_barrier
    s_setprio 2
    ds_read_b64_tr_b16 v[40:41], v16 offset:0
    ds_read_b64_tr_b16 v[42:43], v16 offset:2048
    ds_read_b64_tr_b16 v[44:45], v16 offset:4096
    ds_read_b64_tr_b16 v[46:47], v16 offset:6144
    ds_read_b64_tr_b16 v[48:49], v16 offset:8192
    ds_read_b64_tr_b16 v[50:51], v16 offset:10240
    ds_read_b64_tr_b16 v[52:53], v16 offset:12288
    ds_read_b64_tr_b16 v[54:55], v16 offset:14336
    ds_read_b64_tr_b16 v[32:33], v16 offset:16384
    ds_read_b64_tr_b16 v[34:35], v16 offset:18432
    s_waitcnt lgkmcnt(6)
    v_mfma_f32_32x32x16_bf16 v[56:71], v[40:43], v[88:91], 0
    v_mfma_f32_16x16x32_bf16 v[12:15], v[8:11], v[88:91], 0
    ds_read_b64_tr_b16 v[36:37], v16 offset:20480
    ds_read_b64_tr_b16 v[38:39], v16 offset:22528
    v_mfma_f32_32x32x16_bf16 v[56:71], v[44:47], v[92:95], v[56:71]
    v_mfma_f32_16x16x32_bf16 v[12:15], v[8:11], v[92:95], v[12:15]
    ds_read_b64_tr_b16 v[40:41], v16 offset:24576
    ds_read_b64_tr_b16 v[42:43], v16 offset:26624
    s_waitcnt lgkmcnt(6)
    v_mfma_f32_32x32x16_bf16 v[56:71], v[48:51], v[96:99], v[56:71]
    v_mfma_f32_16x16x32_bf16 v[12:15], v[8:11], v[96:99], v[12:15]
    ds_read_b64_tr_b16 v[44:45], v16 offset:28672
    ds_read_b64_tr_b16 v[46:47], v16 offset:30720
    v_mfma_f32_32x32x16_bf16 v[56:71], v[52:55], v[100:103], v[56:71]
    v_mfma_f32_16x16x32_bf16 v[12:15], v[8:11], v[100:103], v[12:15]
    ds_read_b64_tr_b16 v[48:49], v16 offset:32768
    ds_read_b64_tr_b16 v[50:51], v16 offset:34816
    s_waitcnt lgkmcnt(6)
    v_mfma_f32_32x32x16_bf16 v[56:71], v[32:35], v[104:107], v[56:71]
    v_mfma_f32_16x16x32_bf16 v[12:15], v[8:11], v[104:107], v[12:15]
    ds_read_b64_tr_b16 v[52:53], v16 offset:36864
    ds_read_b64_tr_b16 v[54:55], v16 offset:38912
    v_mfma_f32_32x32x16_bf16 v[56:71], v[36:39], v[108:111], v[56:71]
    v_mfma_f32_16x16x32_bf16 v[12:15], v[8:11], v[108:111], v[12:15]
    v_add_u32 v16, 0xa000, v16
    ds_read_b64_tr_b16 v[32:33], v16 offset:0
    ds_read_b64_tr_b16 v[34:35], v16 offset:2048
    s_waitcnt lgkmcnt(6)
    v_mfma_f32_32x32x16_bf16 v[56:71], v[40:43], v[112:115], v[56:71]
    v_mfma_f32_16x16x32_bf16 v[12:15], v[8:11], v[112:115], v[12:15]
    ds_read_b64_tr_b16 v[36:37], v16 offset:4096
    ds_read_b64_tr_b16 v[38:39], v16 offset:6144
    v_mfma_f32_32x32x16_bf16 v[56:71], v[44:47], v[116:119], v[56:71]
    v_mfma_f32_16x16x32_bf16 v[12:15], v[8:11], v[116:119], v[12:15]
    ds_read_b64_tr_b16 v[40:41], v16 offset:8192
    ds_read_b64_tr_b16 v[42:43], v16 offset:10240
    s_waitcnt lgkmcnt(6)
    v_mfma_f32_32x32x16_bf16 v[56:71], v[48:51], v[120:123], v[56:71]
    v_mfma_f32_16x16x32_bf16 v[12:15], v[8:11], v[120:123], v[12:15]
    ds_read_b64_tr_b16 v[44:45], v16 offset:12288
    ds_read_b64_tr_b16 v[46:47], v16 offset:14336
    v_mfma_f32_32x32x16_bf16 v[56:71], v[52:55], v[124:127], v[56:71]
    v_mfma_f32_16x16x32_bf16 v[12:15], v[8:11], v[124:127], v[12:15]
    ds_read_b64_tr_b16 v[48:49], v16 offset:16384
    ds_read_b64_tr_b16 v[50:51], v16 offset:18432
    s_waitcnt lgkmcnt(6)
    v_mfma_f32_32x32x16_bf16 v[56:71], v[32:35], v[168:171], v[56:71]
    v_mfma_f32_16x16x32_bf16 v[12:15], v[8:11], v[168:171], v[12:15]
    ds_read_b64_tr_b16 v[52:53], v16 offset:20480
    ds_read_b64_tr_b16 v[54:55], v16 offset:22528
    v_mfma_f32_32x32x16_bf16 v[56:71], v[36:39], v[172:175], v[56:71]
    v_mfma_f32_16x16x32_bf16 v[12:15], v[8:11], v[172:175], v[12:15]
    ds_read_b64_tr_b16 v[32:33], v16 offset:24576
    ds_read_b64_tr_b16 v[34:35], v16 offset:26624
    s_waitcnt lgkmcnt(6)
    v_mfma_f32_32x32x16_bf16 v[56:71], v[40:43], v[176:179], v[56:71]
    v_mfma_f32_16x16x32_bf16 v[12:15], v[8:11], v[176:179], v[12:15]
    ds_read_b64_tr_b16 v[36:37], v16 offset:28672
    ds_read_b64_tr_b16 v[38:39], v16 offset:30720
    v_mfma_f32_32x32x16_bf16 v[56:71], v[44:47], v[180:183], v[56:71]
    v_mfma_f32_16x16x32_bf16 v[12:15], v[8:11], v[180:183], v[12:15]
    ds_read_b64_tr_b16 v[40:41], v16 offset:32768
    ds_read_b64_tr_b16 v[42:43], v16 offset:34816
    s_waitcnt lgkmcnt(6)
    v_mfma_f32_32x32x16_bf16 v[56:71], v[48:51], v[184:187], v[56:71]
    v_mfma_f32_16x16x32_bf16 v[12:15], v[8:11], v[184:187], v[12:15]
    ds_read_b64_tr_b16 v[44:45], v16 offset:36864
    ds_read_b64_tr_b16 v[46:47], v16 offset:38912
    v_mfma_f32_32x32x16_bf16 v[56:71], v[52:55], v[188:191], v[56:71]
    v_mfma_f32_16x16x32_bf16 v[12:15], v[8:11], v[188:191], v[12:15]
    ds_read_b64_tr_b16 v[48:49], v17 offset:0
    ds_read_b64_tr_b16 v[50:51], v17 offset:2048
    s_waitcnt lgkmcnt(6)
    v_mfma_f32_32x32x16_bf16 v[56:71], v[32:35], v[192:195], v[56:71]
    v_mfma_f32_16x16x32_bf16 v[12:15], v[8:11], v[192:195], v[12:15]
    ds_read_b64_tr_b16 v[52:53], v17 offset:4096
    ds_read_b64_tr_b16 v[54:55], v17 offset:6144
    v_mfma_f32_32x32x16_bf16 v[56:71], v[36:39], v[196:199], v[56:71]
    v_mfma_f32_16x16x32_bf16 v[12:15], v[8:11], v[196:199], v[12:15]
    ds_read_b64_tr_b16 v[32:33], v17 offset:8192
    ds_read_b64_tr_b16 v[34:35], v17 offset:10240
    s_waitcnt lgkmcnt(6)
    v_mfma_f32_32x32x16_bf16 v[56:71], v[40:43], v[200:203], v[56:71]
    v_mfma_f32_16x16x32_bf16 v[12:15], v[8:11], v[200:203], v[12:15]
    ds_read_b64_tr_b16 v[36:37], v17 offset:12288
    ds_read_b64_tr_b16 v[38:39], v17 offset:14336
    v_mfma_f32_32x32x16_bf16 v[56:71], v[44:47], v[204:207], v[56:71]
    v_mfma_f32_16x16x32_bf16 v[12:15], v[8:11], v[204:207], v[12:15]
    ds_read_b64_tr_b16 v[40:41], v17 offset:16384
    ds_read_b64_tr_b16 v[42:43], v17 offset:18432
    s_waitcnt lgkmcnt(6)
    v_mfma_f32_32x32x16_bf16 v[72:87], v[48:51], v[88:91], 0
    ds_read_b64_tr_b16 v[44:45], v17 offset:20480
    ds_read_b64_tr_b16 v[46:47], v17 offset:22528
    v_mfma_f32_32x32x16_bf16 v[72:87], v[52:55], v[92:95], v[72:87]
    ds_read_b64_tr_b16 v[48:49], v17 offset:24576
    ds_read_b64_tr_b16 v[50:51], v17 offset:26624
    s_waitcnt lgkmcnt(6)
    v_mfma_f32_32x32x16_bf16 v[72:87], v[32:35], v[96:99], v[72:87]
    ds_read_b64_tr_b16 v[52:53], v17 offset:28672
    ds_read_b64_tr_b16 v[54:55], v17 offset:30720
    v_mfma_f32_32x32x16_bf16 v[72:87], v[36:39], v[100:103], v[72:87]
    v_rcp_f32 v25, v12
    s_nop 0
    v_mul_f32 v56, v56, v25
    v_mul_f32 v57, v57, v25
    v_mul_f32 v58, v58, v25
    v_mul_f32 v59, v59, v25
    v_mul_f32 v60, v60, v25
    v_mul_f32 v61, v61, v25
    ds_read_b64_tr_b16 v[32:33], v17 offset:32768
    ds_read_b64_tr_b16 v[34:35], v17 offset:34816
    s_waitcnt lgkmcnt(6)
    v_mfma_f32_32x32x16_bf16 v[72:87], v[40:43], v[104:107], v[72:87]
    v_mul_f32 v62, v62, v25
    v_mul_f32 v63, v63, v25
    v_mul_f32 v64, v64, v25
    v_mul_f32 v65, v65, v25
    v_mul_f32 v66, v66, v25
    v_mul_f32 v67, v67, v25
    v_mul_f32 v68, v68, v25
    v_mul_f32 v69, v69, v25
    ds_read_b64_tr_b16 v[36:37], v17 offset:36864
    ds_read_b64_tr_b16 v[38:39], v17 offset:38912
    v_mfma_f32_32x32x16_bf16 v[72:87], v[44:47], v[108:111], v[72:87]
    v_mul_f32 v70, v70, v25
    v_mul_f32 v71, v71, v25
    v_cvt_pk_bf16_f32 v56, v56, v57
    v_cvt_pk_bf16_f32 v57, v58, v59
    v_cvt_pk_bf16_f32 v58, v60, v61
    v_cvt_pk_bf16_f32 v59, v62, v63
    v_cvt_pk_bf16_f32 v60, v64, v65
    v_cvt_pk_bf16_f32 v61, v66, v67
    v_add_u32 v17, 0xa000, v17
    ds_read_b64_tr_b16 v[40:41], v17 offset:0
    ds_read_b64_tr_b16 v[42:43], v17 offset:2048
    s_waitcnt lgkmcnt(6)
    v_mfma_f32_32x32x16_bf16 v[72:87], v[48:51], v[112:115], v[72:87]
    v_cvt_pk_bf16_f32 v62, v68, v69
    v_cvt_pk_bf16_f32 v63, v70, v71
    ds_read_b64_tr_b16 v[44:45], v17 offset:4096
    ds_read_b64_tr_b16 v[46:47], v17 offset:6144
    v_mfma_f32_32x32x16_bf16 v[72:87], v[52:55], v[116:119], v[72:87]
    ds_read_b64_tr_b16 v[48:49], v17 offset:8192
    ds_read_b64_tr_b16 v[50:51], v17 offset:10240
    s_waitcnt lgkmcnt(6)
    v_mfma_f32_32x32x16_bf16 v[72:87], v[32:35], v[120:123], v[72:87]
    ds_read_b64_tr_b16 v[52:53], v17 offset:12288
    ds_read_b64_tr_b16 v[54:55], v17 offset:14336
    v_mfma_f32_32x32x16_bf16 v[72:87], v[36:39], v[124:127], v[72:87]
    ds_read_b64_tr_b16 v[32:33], v17 offset:16384
    ds_read_b64_tr_b16 v[34:35], v17 offset:18432
    s_waitcnt lgkmcnt(6)
    v_mfma_f32_32x32x16_bf16 v[72:87], v[40:43], v[168:171], v[72:87]
    ds_read_b64_tr_b16 v[36:37], v17 offset:20480
    ds_read_b64_tr_b16 v[38:39], v17 offset:22528
    v_mfma_f32_32x32x16_bf16 v[72:87], v[44:47], v[172:175], v[72:87]
    ds_read_b64_tr_b16 v[40:41], v17 offset:24576
    ds_read_b64_tr_b16 v[42:43], v17 offset:26624
    s_waitcnt lgkmcnt(6)
    v_mfma_f32_32x32x16_bf16 v[72:87], v[48:51], v[176:179], v[72:87]
    ds_read_b64_tr_b16 v[44:45], v17 offset:28672
    ds_read_b64_tr_b16 v[46:47], v17 offset:30720
    v_mfma_f32_32x32x16_bf16 v[72:87], v[52:55], v[180:183], v[72:87]
    ds_read_b64_tr_b16 v[48:49], v17 offset:32768
    ds_read_b64_tr_b16 v[50:51], v17 offset:34816
    s_waitcnt lgkmcnt(6)
    v_mfma_f32_32x32x16_bf16 v[72:87], v[32:35], v[184:187], v[72:87]
    ds_read_b64_tr_b16 v[52:53], v17 offset:36864
    ds_read_b64_tr_b16 v[54:55], v17 offset:38912
    v_mfma_f32_32x32x16_bf16 v[72:87], v[36:39], v[188:191], v[72:87]
    ds_read_b64_tr_b16 v[32:33], v18 offset:0
    ds_read_b64_tr_b16 v[34:35], v18 offset:2048
    s_waitcnt lgkmcnt(6)
    v_mfma_f32_32x32x16_bf16 v[72:87], v[40:43], v[192:195], v[72:87]
    ds_read_b64_tr_b16 v[36:37], v18 offset:4096
    ds_read_b64_tr_b16 v[38:39], v18 offset:6144
    v_mfma_f32_32x32x16_bf16 v[72:87], v[44:47], v[196:199], v[72:87]
    ds_read_b64_tr_b16 v[40:41], v18 offset:8192
    ds_read_b64_tr_b16 v[42:43], v18 offset:10240
    s_waitcnt lgkmcnt(6)
    v_mfma_f32_32x32x16_bf16 v[72:87], v[48:51], v[200:203], v[72:87]
    ds_read_b64_tr_b16 v[44:45], v18 offset:12288
    ds_read_b64_tr_b16 v[46:47], v18 offset:14336
    v_mfma_f32_32x32x16_bf16 v[72:87], v[52:55], v[204:207], v[72:87]
    ds_read_b64_tr_b16 v[48:49], v18 offset:16384
    ds_read_b64_tr_b16 v[50:51], v18 offset:18432
    s_waitcnt lgkmcnt(6)
    v_mfma_f32_32x32x16_bf16 v[136:151], v[32:35], v[88:91], 0
    ds_read_b64_tr_b16 v[52:53], v18 offset:20480
    ds_read_b64_tr_b16 v[54:55], v18 offset:22528
    v_mfma_f32_32x32x16_bf16 v[136:151], v[36:39], v[92:95], v[136:151]
    ds_read_b64_tr_b16 v[32:33], v18 offset:24576
    ds_read_b64_tr_b16 v[34:35], v18 offset:26624
    s_waitcnt lgkmcnt(6)
    v_mfma_f32_32x32x16_bf16 v[136:151], v[40:43], v[96:99], v[136:151]
    ds_read_b64_tr_b16 v[36:37], v18 offset:28672
    ds_read_b64_tr_b16 v[38:39], v18 offset:30720
    v_mfma_f32_32x32x16_bf16 v[136:151], v[44:47], v[100:103], v[136:151]
    ds_read_b64_tr_b16 v[40:41], v18 offset:32768
    ds_read_b64_tr_b16 v[42:43], v18 offset:34816
    s_waitcnt lgkmcnt(6)
    v_mfma_f32_32x32x16_bf16 v[136:151], v[48:51], v[104:107], v[136:151]
    v_mul_f32 v72, v72, v25
    v_mul_f32 v73, v73, v25
    v_mul_f32 v74, v74, v25
    v_mul_f32 v75, v75, v25
    v_mul_f32 v76, v76, v25
    v_mul_f32 v77, v77, v25
    v_mul_f32 v78, v78, v25
    v_mul_f32 v79, v79, v25
    ds_read_b64_tr_b16 v[44:45], v18 offset:36864
    ds_read_b64_tr_b16 v[46:47], v18 offset:38912
    v_mfma_f32_32x32x16_bf16 v[136:151], v[52:55], v[108:111], v[136:151]
    v_mul_f32 v80, v80, v25
    v_mul_f32 v81, v81, v25
    v_mul_f32 v82, v82, v25
    v_mul_f32 v83, v83, v25
    v_mul_f32 v84, v84, v25
    v_mul_f32 v85, v85, v25
    v_mul_f32 v86, v86, v25
    v_mul_f32 v87, v87, v25
    v_add_u32 v18, 0xa000, v18
    ds_read_b64_tr_b16 v[48:49], v18 offset:0
    ds_read_b64_tr_b16 v[50:51], v18 offset:2048
    s_waitcnt lgkmcnt(6)
    v_mfma_f32_32x32x16_bf16 v[136:151], v[32:35], v[112:115], v[136:151]
    v_cvt_pk_bf16_f32 v72, v72, v73
    v_cvt_pk_bf16_f32 v73, v74, v75
    v_cvt_pk_bf16_f32 v74, v76, v77
    v_cvt_pk_bf16_f32 v75, v78, v79
    v_cvt_pk_bf16_f32 v76, v80, v81
    v_cvt_pk_bf16_f32 v77, v82, v83
    v_cvt_pk_bf16_f32 v78, v84, v85
    v_cvt_pk_bf16_f32 v79, v86, v87
    ds_read_b64_tr_b16 v[52:53], v18 offset:4096
    ds_read_b64_tr_b16 v[54:55], v18 offset:6144
    v_mfma_f32_32x32x16_bf16 v[136:151], v[36:39], v[116:119], v[136:151]
    v_permlane16_swap_b32 v56, v72
    v_permlane16_swap_b32 v57, v73
    v_permlane16_swap_b32 v58, v74
    v_permlane16_swap_b32 v59, v75
    v_permlane16_swap_b32 v60, v76
    v_permlane16_swap_b32 v61, v77
    v_permlane16_swap_b32 v62, v78
    v_permlane16_swap_b32 v63, v79
    ds_read_b64_tr_b16 v[32:33], v18 offset:8192
    ds_read_b64_tr_b16 v[34:35], v18 offset:10240
    s_waitcnt lgkmcnt(6)
    v_mfma_f32_32x32x16_bf16 v[136:151], v[40:43], v[120:123], v[136:151]
    buffer_store_dwordx4 v[56:59], v20, s[24:27], s30 offen offset:0 sc1 nt
    buffer_store_dwordx4 v[72:75], v21, s[24:27], s30 offen offset:0 sc1 nt
    buffer_store_dwordx4 v[60:63], v20, s[24:27], s30 offen offset:128 sc1 nt
    buffer_store_dwordx4 v[76:79], v21, s[24:27], s30 offen offset:128 sc1 nt
    ds_read_b64_tr_b16 v[36:37], v18 offset:12288
    ds_read_b64_tr_b16 v[38:39], v18 offset:14336
    v_mfma_f32_32x32x16_bf16 v[136:151], v[44:47], v[124:127], v[136:151]
    ds_read_b64_tr_b16 v[40:41], v18 offset:16384
    ds_read_b64_tr_b16 v[42:43], v18 offset:18432
    s_waitcnt lgkmcnt(6)
    v_mfma_f32_32x32x16_bf16 v[136:151], v[48:51], v[168:171], v[136:151]
    ds_read_b64_tr_b16 v[44:45], v18 offset:20480
    ds_read_b64_tr_b16 v[46:47], v18 offset:22528
    v_mfma_f32_32x32x16_bf16 v[136:151], v[52:55], v[172:175], v[136:151]
    ds_read_b64_tr_b16 v[48:49], v18 offset:24576
    ds_read_b64_tr_b16 v[50:51], v18 offset:26624
    s_waitcnt lgkmcnt(6)
    v_mfma_f32_32x32x16_bf16 v[136:151], v[32:35], v[176:179], v[136:151]
    ds_read_b64_tr_b16 v[52:53], v18 offset:28672
    ds_read_b64_tr_b16 v[54:55], v18 offset:30720
    v_mfma_f32_32x32x16_bf16 v[136:151], v[36:39], v[180:183], v[136:151]
    ds_read_b64_tr_b16 v[32:33], v18 offset:32768
    ds_read_b64_tr_b16 v[34:35], v18 offset:34816
    s_waitcnt lgkmcnt(6)
    v_mfma_f32_32x32x16_bf16 v[136:151], v[40:43], v[184:187], v[136:151]
    ds_read_b64_tr_b16 v[36:37], v18 offset:36864
    ds_read_b64_tr_b16 v[38:39], v18 offset:38912
    v_mfma_f32_32x32x16_bf16 v[136:151], v[44:47], v[188:191], v[136:151]
    ds_read_b64_tr_b16 v[40:41], v19 offset:0
    ds_read_b64_tr_b16 v[42:43], v19 offset:2048
    s_waitcnt lgkmcnt(6)
    v_mfma_f32_32x32x16_bf16 v[136:151], v[48:51], v[192:195], v[136:151]
    ds_read_b64_tr_b16 v[44:45], v19 offset:4096
    ds_read_b64_tr_b16 v[46:47], v19 offset:6144
    v_mfma_f32_32x32x16_bf16 v[136:151], v[52:55], v[196:199], v[136:151]
    ds_read_b64_tr_b16 v[48:49], v19 offset:8192
    ds_read_b64_tr_b16 v[50:51], v19 offset:10240
    s_waitcnt lgkmcnt(6)
    v_mfma_f32_32x32x16_bf16 v[136:151], v[32:35], v[200:203], v[136:151]
    ds_read_b64_tr_b16 v[52:53], v19 offset:12288
    ds_read_b64_tr_b16 v[54:55], v19 offset:14336
    v_mfma_f32_32x32x16_bf16 v[136:151], v[36:39], v[204:207], v[136:151]
    ds_read_b64_tr_b16 v[32:33], v19 offset:16384
    ds_read_b64_tr_b16 v[34:35], v19 offset:18432
    s_waitcnt lgkmcnt(6)
    v_mfma_f32_32x32x16_bf16 v[152:167], v[40:43], v[88:91], 0
    ds_read_b64_tr_b16 v[36:37], v19 offset:20480
    ds_read_b64_tr_b16 v[38:39], v19 offset:22528
    v_mfma_f32_32x32x16_bf16 v[152:167], v[44:47], v[92:95], v[152:167]
    ds_read_b64_tr_b16 v[40:41], v19 offset:24576
    ds_read_b64_tr_b16 v[42:43], v19 offset:26624
    s_waitcnt lgkmcnt(6)
    v_mfma_f32_32x32x16_bf16 v[152:167], v[48:51], v[96:99], v[152:167]
    ds_read_b64_tr_b16 v[44:45], v19 offset:28672
    ds_read_b64_tr_b16 v[46:47], v19 offset:30720
    v_mfma_f32_32x32x16_bf16 v[152:167], v[52:55], v[100:103], v[152:167]
    ds_read_b64_tr_b16 v[48:49], v19 offset:32768
    ds_read_b64_tr_b16 v[50:51], v19 offset:34816
    s_waitcnt lgkmcnt(6)
    v_mfma_f32_32x32x16_bf16 v[152:167], v[32:35], v[104:107], v[152:167]
    v_mul_f32 v136, v136, v25
    v_mul_f32 v137, v137, v25
    v_mul_f32 v138, v138, v25
    v_mul_f32 v139, v139, v25
    v_mul_f32 v140, v140, v25
    v_mul_f32 v141, v141, v25
    v_mul_f32 v142, v142, v25
    v_mul_f32 v143, v143, v25
    ds_read_b64_tr_b16 v[52:53], v19 offset:36864
    ds_read_b64_tr_b16 v[54:55], v19 offset:38912
    v_mfma_f32_32x32x16_bf16 v[152:167], v[36:39], v[108:111], v[152:167]
    v_mul_f32 v144, v144, v25
    v_mul_f32 v145, v145, v25
    v_mul_f32 v146, v146, v25
    v_mul_f32 v147, v147, v25
    v_mul_f32 v148, v148, v25
    v_mul_f32 v149, v149, v25
    v_mul_f32 v150, v150, v25
    v_mul_f32 v151, v151, v25
    v_add_u32 v19, 0xa000, v19
    ds_read_b64_tr_b16 v[32:33], v19 offset:0
    ds_read_b64_tr_b16 v[34:35], v19 offset:2048
    s_waitcnt lgkmcnt(6)
    v_mfma_f32_32x32x16_bf16 v[152:167], v[40:43], v[112:115], v[152:167]
    v_cvt_pk_bf16_f32 v136, v136, v137
    v_cvt_pk_bf16_f32 v137, v138, v139
    v_cvt_pk_bf16_f32 v138, v140, v141
    v_cvt_pk_bf16_f32 v139, v142, v143
    v_cvt_pk_bf16_f32 v140, v144, v145
    v_cvt_pk_bf16_f32 v141, v146, v147
    v_cvt_pk_bf16_f32 v142, v148, v149
    v_cvt_pk_bf16_f32 v143, v150, v151
    ds_read_b64_tr_b16 v[36:37], v19 offset:4096
    ds_read_b64_tr_b16 v[38:39], v19 offset:6144
    v_mfma_f32_32x32x16_bf16 v[152:167], v[44:47], v[116:119], v[152:167]
    ds_read_b64_tr_b16 v[40:41], v19 offset:8192
    ds_read_b64_tr_b16 v[42:43], v19 offset:10240
    s_waitcnt lgkmcnt(6)
    v_mfma_f32_32x32x16_bf16 v[152:167], v[48:51], v[120:123], v[152:167]
    ds_read_b64_tr_b16 v[44:45], v19 offset:12288
    ds_read_b64_tr_b16 v[46:47], v19 offset:14336
    v_mfma_f32_32x32x16_bf16 v[152:167], v[52:55], v[124:127], v[152:167]
    ds_read_b64_tr_b16 v[48:49], v19 offset:16384
    ds_read_b64_tr_b16 v[50:51], v19 offset:18432
    s_waitcnt lgkmcnt(6)
    v_mfma_f32_32x32x16_bf16 v[152:167], v[32:35], v[168:171], v[152:167]
    ds_read_b64_tr_b16 v[52:53], v19 offset:20480
    ds_read_b64_tr_b16 v[54:55], v19 offset:22528
    v_mfma_f32_32x32x16_bf16 v[152:167], v[36:39], v[172:175], v[152:167]
    ds_read_b64_tr_b16 v[32:33], v19 offset:24576
    ds_read_b64_tr_b16 v[34:35], v19 offset:26624
    s_waitcnt lgkmcnt(6)
    v_mfma_f32_32x32x16_bf16 v[152:167], v[40:43], v[176:179], v[152:167]
    ds_read_b64_tr_b16 v[36:37], v19 offset:28672
    ds_read_b64_tr_b16 v[38:39], v19 offset:30720
    v_mfma_f32_32x32x16_bf16 v[152:167], v[44:47], v[180:183], v[152:167]
    ds_read_b64_tr_b16 v[40:41], v19 offset:32768
    ds_read_b64_tr_b16 v[42:43], v19 offset:34816
    s_waitcnt lgkmcnt(6)
    v_mfma_f32_32x32x16_bf16 v[152:167], v[48:51], v[184:187], v[152:167]
    ds_read_b64_tr_b16 v[44:45], v19 offset:36864
    ds_read_b64_tr_b16 v[46:47], v19 offset:38912
    v_mfma_f32_32x32x16_bf16 v[152:167], v[52:55], v[188:191], v[152:167]
    s_waitcnt lgkmcnt(4)
    v_mfma_f32_32x32x16_bf16 v[152:167], v[32:35], v[192:195], v[152:167]
    v_mfma_f32_32x32x16_bf16 v[152:167], v[36:39], v[196:199], v[152:167]
    s_waitcnt lgkmcnt(0)
    v_mfma_f32_32x32x16_bf16 v[152:167], v[40:43], v[200:203], v[152:167]
    v_mfma_f32_32x32x16_bf16 v[152:167], v[44:47], v[204:207], v[152:167]
    s_nop 11
    v_mul_f32 v152, v152, v25
    v_mul_f32 v153, v153, v25
    v_mul_f32 v154, v154, v25
    v_mul_f32 v155, v155, v25
    v_mul_f32 v156, v156, v25
    v_mul_f32 v157, v157, v25
    v_mul_f32 v158, v158, v25
    v_mul_f32 v159, v159, v25
    v_mul_f32 v160, v160, v25
    v_mul_f32 v161, v161, v25
    v_mul_f32 v162, v162, v25
    v_mul_f32 v163, v163, v25
    v_mul_f32 v164, v164, v25
    v_mul_f32 v165, v165, v25
    v_mul_f32 v166, v166, v25
    v_mul_f32 v167, v167, v25
    v_cvt_pk_bf16_f32 v152, v152, v153
    v_cvt_pk_bf16_f32 v153, v154, v155
    v_cvt_pk_bf16_f32 v154, v156, v157
    v_cvt_pk_bf16_f32 v155, v158, v159
    v_cvt_pk_bf16_f32 v156, v160, v161
    v_cvt_pk_bf16_f32 v157, v162, v163
    v_cvt_pk_bf16_f32 v158, v164, v165
    v_cvt_pk_bf16_f32 v159, v166, v167
    v_permlane16_swap_b32 v136, v152
    v_permlane16_swap_b32 v137, v153
    v_permlane16_swap_b32 v138, v154
    v_permlane16_swap_b32 v139, v155
    v_permlane16_swap_b32 v140, v156
    v_permlane16_swap_b32 v141, v157
    v_permlane16_swap_b32 v142, v158
    v_permlane16_swap_b32 v143, v159
    buffer_store_dwordx4 v[136:139], v20, s[24:27], s30 offen offset:64 sc1 nt
    buffer_store_dwordx4 v[152:155], v21, s[24:27], s30 offen offset:64 sc1 nt
    buffer_store_dwordx4 v[140:143], v20, s[24:27], s30 offen offset:192 sc1 nt
    buffer_store_dwordx4 v[156:159], v21, s[24:27], s30 offen offset:192 sc1 nt

    v_and_b32 v241, 31, v0
    v_lshrrev_b32 v242, 5, v0
    v_and_b32 v243, 15, v0
    v_lshrrev_b32 v244, 4, v0
    v_lshrrev_b32 v245, 2, v0
    v_and_b32 v245, 3, v245
    v_and_b32 v246, 3, v0

    v_xor_b32 v247, v244, v243
    v_lshlrev_b32 v247, 4, v247
    v_lshl_or_b32 v208, v243, 8, v247
    v_xor_b32 v209, 64, v208
    v_xor_b32 v210, 0x80, v208
    v_xor_b32 v211, 0xc0, v208
    v_lshl_add_u32 v247, v244, 2, v245
    v_lshlrev_b32 v247, 8, v247
    v_lshrrev_b32 v212, 1, v246
    v_lshlrev_b32 v212, 3, v212
    v_lshl_add_u32 v212, v245, 1, v212
    v_and_b32 v213, 1, v244
    v_add_u32 v212, v212, v213
    v_lshl_add_u32 v247, v212, 4, v247
    v_and_b32 v212, 1, v246
    v_lshl_add_u32 v247, v212, 3, v247
    v_add_u32 v212, 0x14000, v247
    v_xor_b32 v213, 16, v212
    v_xor_b32 v214, 32, v212
    v_xor_b32 v215, 48, v212
    v_xor_b32 v216, 64, v212
    v_xor_b32 v217, 0x50, v212
    v_xor_b32 v218, 0x60, v212
    v_xor_b32 v219, 0x70, v212
    v_add_u32 v247, s40, v243
    v_lshlrev_b32 v247, 8, v247
    v_lshl_add_u32 v220, v244, 4, v247

    s_waitcnt vmcnt(8)
    s_setprio 2
    ds_read_b128 v[32:35], v208 offset:0
    ds_read_b128 v[36:39], v209 offset:0
    ds_read_b128 v[40:43], v210 offset:0
    ds_read_b128 v[44:47], v211 offset:0
    ds_read_b128 v[48:51], v208 offset:4096
    ds_read_b128 v[52:55], v209 offset:4096
    ds_read_b128 v[224:227], v210 offset:4096
    ds_read_b128 v[228:231], v211 offset:4096
    ds_read_b128 v[232:235], v208 offset:8192
    s_waitcnt lgkmcnt(5)
    v_mfma_f32_16x16x32_bf16 v[56:59], v[32:35], v[248:251], 0
    ds_read_b128 v[236:239], v209 offset:8192
    v_mfma_f32_16x16x32_bf16 v[56:59], v[36:39], v[252:255], v[56:59]
    ds_read_b128 v[32:35], v210 offset:8192
    v_mfma_f32_16x16x32_bf16 v[56:59], v[40:43], v[4:7], v[56:59]
    ds_read_b128 v[36:39], v211 offset:8192
    v_mfma_f32_16x16x32_bf16 v[56:59], v[44:47], v[28:31], v[56:59]
    ds_read_b128 v[40:43], v208 offset:12288
    s_waitcnt lgkmcnt(5)
    v_mfma_f32_16x16x32_bf16 v[60:63], v[48:51], v[248:251], 0
    ds_read_b128 v[44:47], v209 offset:12288
    v_mfma_f32_16x16x32_bf16 v[60:63], v[52:55], v[252:255], v[60:63]
    ds_read_b128 v[48:51], v210 offset:12288
    v_mfma_f32_16x16x32_bf16 v[60:63], v[224:227], v[4:7], v[60:63]
    ds_read_b128 v[52:55], v211 offset:12288
    v_mfma_f32_16x16x32_bf16 v[60:63], v[228:231], v[28:31], v[60:63]
    ds_read_b128 v[224:227], v208 offset:16384
    s_waitcnt lgkmcnt(5)
    v_mfma_f32_16x16x32_bf16 v[64:67], v[232:235], v[248:251], 0
    v_max_f32 v22, v56, v57
    v_max3_f32 v22, v22, v58, v59
    ds_read_b128 v[228:231], v209 offset:16384
    v_mfma_f32_16x16x32_bf16 v[64:67], v[236:239], v[252:255], v[64:67]
    ds_read_b128 v[232:235], v210 offset:16384
    v_mfma_f32_16x16x32_bf16 v[64:67], v[32:35], v[4:7], v[64:67]
    ds_read_b128 v[236:239], v211 offset:16384
    v_mfma_f32_16x16x32_bf16 v[64:67], v[36:39], v[28:31], v[64:67]
    v_max3_f32 v22, v22, v60, v61
    v_max3_f32 v22, v22, v62, v63
    ds_read_b128 v[32:35], v208 offset:20480
    s_waitcnt lgkmcnt(5)
    v_mfma_f32_16x16x32_bf16 v[68:71], v[40:43], v[248:251], 0
    ds_read_b128 v[36:39], v209 offset:20480
    v_mfma_f32_16x16x32_bf16 v[68:71], v[44:47], v[252:255], v[68:71]
    ds_read_b128 v[40:43], v210 offset:20480
    v_mfma_f32_16x16x32_bf16 v[68:71], v[48:51], v[4:7], v[68:71]
    ds_read_b128 v[44:47], v211 offset:20480
    v_mfma_f32_16x16x32_bf16 v[68:71], v[52:55], v[28:31], v[68:71]
    v_max3_f32 v22, v22, v64, v65
    v_max3_f32 v22, v22, v66, v67
    ds_read_b128 v[48:51], v208 offset:24576
    s_waitcnt lgkmcnt(5)
    v_mfma_f32_16x16x32_bf16 v[72:75], v[224:227], v[248:251], 0
    ds_read_b128 v[52:55], v209 offset:24576
    v_mfma_f32_16x16x32_bf16 v[72:75], v[228:231], v[252:255], v[72:75]
    ds_read_b128 v[224:227], v210 offset:24576
    v_mfma_f32_16x16x32_bf16 v[72:75], v[232:235], v[4:7], v[72:75]
    ds_read_b128 v[228:231], v211 offset:24576
    v_mfma_f32_16x16x32_bf16 v[72:75], v[236:239], v[28:31], v[72:75]
    v_max3_f32 v22, v22, v68, v69
    v_max3_f32 v22, v22, v70, v71
    ds_read_b128 v[232:235], v208 offset:28672
    s_waitcnt lgkmcnt(5)
    v_mfma_f32_16x16x32_bf16 v[76:79], v[32:35], v[248:251], 0
    ds_read_b128 v[236:239], v209 offset:28672
    v_mfma_f32_16x16x32_bf16 v[76:79], v[36:39], v[252:255], v[76:79]
    ds_read_b128 v[32:35], v210 offset:28672
    v_mfma_f32_16x16x32_bf16 v[76:79], v[40:43], v[4:7], v[76:79]
    ds_read_b128 v[36:39], v211 offset:28672
    v_mfma_f32_16x16x32_bf16 v[76:79], v[44:47], v[28:31], v[76:79]
    v_max3_f32 v22, v22, v72, v73
    v_max3_f32 v22, v22, v74, v75
    ds_read_b128 v[40:43], v208 offset:32768
    s_waitcnt lgkmcnt(5)
    v_mfma_f32_16x16x32_bf16 v[80:83], v[48:51], v[248:251], 0
    ds_read_b128 v[44:47], v209 offset:32768
    v_mfma_f32_16x16x32_bf16 v[80:83], v[52:55], v[252:255], v[80:83]
    ds_read_b128 v[48:51], v210 offset:32768
    v_mfma_f32_16x16x32_bf16 v[80:83], v[224:227], v[4:7], v[80:83]
    ds_read_b128 v[52:55], v211 offset:32768
    v_mfma_f32_16x16x32_bf16 v[80:83], v[228:231], v[28:31], v[80:83]
    v_max3_f32 v22, v22, v76, v77
    v_max3_f32 v22, v22, v78, v79
    ds_read_b128 v[224:227], v208 offset:36864
    s_waitcnt lgkmcnt(5)
    v_mfma_f32_16x16x32_bf16 v[84:87], v[232:235], v[248:251], 0
    ds_read_b128 v[228:231], v209 offset:36864
    v_mfma_f32_16x16x32_bf16 v[84:87], v[236:239], v[252:255], v[84:87]
    ds_read_b128 v[232:235], v210 offset:36864
    v_mfma_f32_16x16x32_bf16 v[84:87], v[32:35], v[4:7], v[84:87]
    ds_read_b128 v[236:239], v211 offset:36864
    v_mfma_f32_16x16x32_bf16 v[84:87], v[36:39], v[28:31], v[84:87]
    v_max3_f32 v22, v22, v80, v81
    v_max3_f32 v22, v22, v82, v83
    v_add_u32 v208, 0xa000, v208
    v_add_u32 v209, 0xa000, v209
    v_add_u32 v210, 0xa000, v210
    v_add_u32 v211, 0xa000, v211
    ds_read_b128 v[32:35], v208 offset:0
    s_waitcnt lgkmcnt(5)
    v_mfma_f32_16x16x32_bf16 v[88:91], v[40:43], v[248:251], 0
    ds_read_b128 v[36:39], v209 offset:0
    v_mfma_f32_16x16x32_bf16 v[88:91], v[44:47], v[252:255], v[88:91]
    v_max3_f32 v22, v22, v84, v85
    v_max3_f32 v22, v22, v86, v87
    ds_read_b128 v[40:43], v210 offset:0
    v_mfma_f32_16x16x32_bf16 v[88:91], v[48:51], v[4:7], v[88:91]
    ds_read_b128 v[44:47], v211 offset:0
    v_mfma_f32_16x16x32_bf16 v[88:91], v[52:55], v[28:31], v[88:91]
    ds_read_b128 v[48:51], v208 offset:4096
    s_waitcnt lgkmcnt(5)
    v_mfma_f32_16x16x32_bf16 v[92:95], v[224:227], v[248:251], 0
    ds_read_b128 v[52:55], v209 offset:4096
    v_mfma_f32_16x16x32_bf16 v[92:95], v[228:231], v[252:255], v[92:95]
    ds_read_b128 v[224:227], v210 offset:4096
    v_mfma_f32_16x16x32_bf16 v[92:95], v[232:235], v[4:7], v[92:95]
    ds_read_b128 v[228:231], v211 offset:4096
    v_mfma_f32_16x16x32_bf16 v[92:95], v[236:239], v[28:31], v[92:95]
    ds_read_b128 v[232:235], v208 offset:8192
    s_waitcnt lgkmcnt(5)
    v_mfma_f32_16x16x32_bf16 v[136:139], v[32:35], v[248:251], 0
    v_max3_f32 v22, v22, v88, v89
    v_max3_f32 v22, v22, v90, v91
    ds_read_b128 v[236:239], v209 offset:8192
    v_mfma_f32_16x16x32_bf16 v[136:139], v[36:39], v[252:255], v[136:139]
    ds_read_b128 v[32:35], v210 offset:8192
    v_mfma_f32_16x16x32_bf16 v[136:139], v[40:43], v[4:7], v[136:139]
    ds_read_b128 v[36:39], v211 offset:8192
    v_mfma_f32_16x16x32_bf16 v[136:139], v[44:47], v[28:31], v[136:139]
    v_max3_f32 v22, v22, v92, v93
    v_max3_f32 v22, v22, v94, v95
    ds_read_b128 v[40:43], v208 offset:12288
    s_waitcnt lgkmcnt(5)
    v_mfma_f32_16x16x32_bf16 v[140:143], v[48:51], v[248:251], 0
    ds_read_b128 v[44:47], v209 offset:12288
    v_mfma_f32_16x16x32_bf16 v[140:143], v[52:55], v[252:255], v[140:143]
    ds_read_b128 v[48:51], v210 offset:12288
    v_mfma_f32_16x16x32_bf16 v[140:143], v[224:227], v[4:7], v[140:143]
    ds_read_b128 v[52:55], v211 offset:12288
    v_mfma_f32_16x16x32_bf16 v[140:143], v[228:231], v[28:31], v[140:143]
    v_max3_f32 v23, v22, v136, v137
    v_max3_f32 v23, v23, v138, v139
    ds_read_b128 v[224:227], v208 offset:16384
    s_waitcnt lgkmcnt(5)
    v_mfma_f32_16x16x32_bf16 v[144:147], v[232:235], v[248:251], 0
    ds_read_b128 v[228:231], v209 offset:16384
    v_mfma_f32_16x16x32_bf16 v[144:147], v[236:239], v[252:255], v[144:147]
    ds_read_b128 v[232:235], v210 offset:16384
    v_mfma_f32_16x16x32_bf16 v[144:147], v[32:35], v[4:7], v[144:147]
    ds_read_b128 v[236:239], v211 offset:16384
    v_mfma_f32_16x16x32_bf16 v[144:147], v[36:39], v[28:31], v[144:147]
    v_max3_f32 v23, v23, v140, v141
    v_max3_f32 v23, v23, v142, v143
    ds_read_b128 v[32:35], v208 offset:20480
    s_waitcnt lgkmcnt(5)
    v_mfma_f32_16x16x32_bf16 v[148:151], v[40:43], v[248:251], 0
    ds_read_b128 v[36:39], v209 offset:20480
    v_mfma_f32_16x16x32_bf16 v[148:151], v[44:47], v[252:255], v[148:151]
    ds_read_b128 v[40:43], v210 offset:20480
    v_mfma_f32_16x16x32_bf16 v[148:151], v[48:51], v[4:7], v[148:151]
    ds_read_b128 v[44:47], v211 offset:20480
    v_mfma_f32_16x16x32_bf16 v[148:151], v[52:55], v[28:31], v[148:151]
    v_max3_f32 v23, v23, v144, v145
    v_max3_f32 v23, v23, v146, v147
    ds_read_b128 v[48:51], v208 offset:24576
    s_waitcnt lgkmcnt(5)
    v_mfma_f32_16x16x32_bf16 v[152:155], v[224:227], v[248:251], 0
    ds_read_b128 v[52:55], v209 offset:24576
    v_mfma_f32_16x16x32_bf16 v[152:155], v[228:231], v[252:255], v[152:155]
    ds_read_b128 v[224:227], v210 offset:24576
    v_mfma_f32_16x16x32_bf16 v[152:155], v[232:235], v[4:7], v[152:155]
    ds_read_b128 v[228:231], v211 offset:24576
    v_mfma_f32_16x16x32_bf16 v[152:155], v[236:239], v[28:31], v[152:155]
    v_max3_f32 v23, v23, v148, v149
    v_max3_f32 v23, v23, v150, v151
    ds_read_b128 v[232:235], v208 offset:28672
    s_waitcnt lgkmcnt(5)
    v_mfma_f32_16x16x32_bf16 v[156:159], v[32:35], v[248:251], 0
    ds_read_b128 v[236:239], v209 offset:28672
    v_mfma_f32_16x16x32_bf16 v[156:159], v[36:39], v[252:255], v[156:159]
    ds_read_b128 v[32:35], v210 offset:28672
    v_mfma_f32_16x16x32_bf16 v[156:159], v[40:43], v[4:7], v[156:159]
    ds_read_b128 v[36:39], v211 offset:28672
    v_mfma_f32_16x16x32_bf16 v[156:159], v[44:47], v[28:31], v[156:159]
    v_max3_f32 v23, v23, v152, v153
    v_max3_f32 v23, v23, v154, v155
    ds_read_b128 v[40:43], v208 offset:32768
    s_waitcnt lgkmcnt(5)
    v_mfma_f32_16x16x32_bf16 v[160:163], v[48:51], v[248:251], 0
    ds_read_b128 v[44:47], v209 offset:32768
    v_mfma_f32_16x16x32_bf16 v[160:163], v[52:55], v[252:255], v[160:163]
    ds_read_b128 v[48:51], v210 offset:32768
    v_mfma_f32_16x16x32_bf16 v[160:163], v[224:227], v[4:7], v[160:163]
    ds_read_b128 v[52:55], v211 offset:32768
    v_mfma_f32_16x16x32_bf16 v[160:163], v[228:231], v[28:31], v[160:163]
    v_max3_f32 v23, v23, v156, v157
    v_max3_f32 v23, v23, v158, v159
    ds_read_b128 v[224:227], v208 offset:36864
    s_waitcnt lgkmcnt(5)
    v_mfma_f32_16x16x32_bf16 v[164:167], v[232:235], v[248:251], 0
    ds_read_b128 v[228:231], v209 offset:36864
    v_mfma_f32_16x16x32_bf16 v[164:167], v[236:239], v[252:255], v[164:167]
    ds_read_b128 v[232:235], v210 offset:36864
    v_mfma_f32_16x16x32_bf16 v[164:167], v[32:35], v[4:7], v[164:167]
    ds_read_b128 v[236:239], v211 offset:36864
    v_mfma_f32_16x16x32_bf16 v[164:167], v[36:39], v[28:31], v[164:167]
    v_max3_f32 v23, v23, v160, v161
    v_max3_f32 v23, v23, v162, v163
    s_waitcnt lgkmcnt(4)
    v_mfma_f32_16x16x32_bf16 v[168:171], v[40:43], v[248:251], 0
    v_mfma_f32_16x16x32_bf16 v[168:171], v[44:47], v[252:255], v[168:171]
    v_mfma_f32_16x16x32_bf16 v[168:171], v[48:51], v[4:7], v[168:171]
    v_mfma_f32_16x16x32_bf16 v[168:171], v[52:55], v[28:31], v[168:171]
    s_waitcnt lgkmcnt(0)
    v_mfma_f32_16x16x32_bf16 v[172:175], v[224:227], v[248:251], 0
    v_mfma_f32_16x16x32_bf16 v[172:175], v[228:231], v[252:255], v[172:175]
    v_mfma_f32_16x16x32_bf16 v[172:175], v[232:235], v[4:7], v[172:175]
    v_mfma_f32_16x16x32_bf16 v[172:175], v[236:239], v[28:31], v[172:175]
    v_max3_f32 v23, v23, v164, v165
    v_max3_f32 v23, v23, v166, v167
    s_nop 0
    v_max3_f32 v23, v23, v168, v169
    v_max3_f32 v23, v23, v170, v171
    s_nop 2
    v_max3_f32 v23, v23, v172, v173
    v_max3_f32 v23, v23, v174, v175
    v_mov_b32 v3, v23
    s_nop 1
    v_permlane16_swap_b32 v23, v3
    v_max_f32 v23, v23, v3
    v_mov_b32 v3, v23
    s_nop 1
    v_permlane32_swap_b32 v23, v3
    v_max_f32 v23, v23, v3
    v_mov_b32 v208, 0x3f803f80
    v_mov_b32 v209, 0x3f803f80
    v_mov_b32 v210, 0x3f803f80
    v_mov_b32 v211, 0x3f803f80
    s_setprio 0
    v_mul_f32 v24, s29, v23
    v_fmamk_f32 v56, v56, 0x3e0293ee, v24
    v_fmamk_f32 v57, v57, 0x3e0293ee, v24
    v_fmamk_f32 v58, v58, 0x3e0293ee, v24
    v_fmamk_f32 v59, v59, 0x3e0293ee, v24
    v_fmamk_f32 v60, v60, 0x3e0293ee, v24
    v_fmamk_f32 v61, v61, 0x3e0293ee, v24
    v_fmamk_f32 v62, v62, 0x3e0293ee, v24
    v_fmamk_f32 v63, v63, 0x3e0293ee, v24
    v_exp_f32 v56, v56
    v_exp_f32 v57, v57
    v_exp_f32 v58, v58
    v_exp_f32 v59, v59
    v_exp_f32 v60, v60
    v_exp_f32 v61, v61
    v_exp_f32 v62, v62
    v_exp_f32 v63, v63
    v_cvt_pk_bf16_f32 v56, v56, v57
    v_cvt_pk_bf16_f32 v57, v58, v59
    v_cvt_pk_bf16_f32 v58, v60, v61
    v_cvt_pk_bf16_f32 v59, v62, v63
    v_fmamk_f32 v64, v64, 0x3e0293ee, v24
    v_fmamk_f32 v65, v65, 0x3e0293ee, v24
    v_fmamk_f32 v66, v66, 0x3e0293ee, v24
    v_fmamk_f32 v67, v67, 0x3e0293ee, v24
    v_fmamk_f32 v68, v68, 0x3e0293ee, v24
    v_fmamk_f32 v69, v69, 0x3e0293ee, v24
    v_fmamk_f32 v70, v70, 0x3e0293ee, v24
    v_fmamk_f32 v71, v71, 0x3e0293ee, v24
    v_exp_f32 v64, v64
    v_exp_f32 v65, v65
    v_exp_f32 v66, v66
    v_exp_f32 v67, v67
    v_exp_f32 v68, v68
    v_exp_f32 v69, v69
    v_exp_f32 v70, v70
    v_exp_f32 v71, v71
    v_cvt_pk_bf16_f32 v60, v64, v65
    v_cvt_pk_bf16_f32 v61, v66, v67
    v_cvt_pk_bf16_f32 v62, v68, v69
    v_cvt_pk_bf16_f32 v63, v70, v71
    v_fmamk_f32 v72, v72, 0x3e0293ee, v24
    v_fmamk_f32 v73, v73, 0x3e0293ee, v24
    v_fmamk_f32 v74, v74, 0x3e0293ee, v24
    v_fmamk_f32 v75, v75, 0x3e0293ee, v24
    v_fmamk_f32 v76, v76, 0x3e0293ee, v24
    v_fmamk_f32 v77, v77, 0x3e0293ee, v24
    v_fmamk_f32 v78, v78, 0x3e0293ee, v24
    v_fmamk_f32 v79, v79, 0x3e0293ee, v24
    v_exp_f32 v72, v72
    v_exp_f32 v73, v73
    v_exp_f32 v74, v74
    v_exp_f32 v75, v75
    v_exp_f32 v76, v76
    v_exp_f32 v77, v77
    v_exp_f32 v78, v78
    v_exp_f32 v79, v79
    v_cvt_pk_bf16_f32 v64, v72, v73
    v_cvt_pk_bf16_f32 v65, v74, v75
    v_cvt_pk_bf16_f32 v66, v76, v77
    v_cvt_pk_bf16_f32 v67, v78, v79
    v_fmamk_f32 v80, v80, 0x3e0293ee, v24
    v_fmamk_f32 v81, v81, 0x3e0293ee, v24
    v_fmamk_f32 v82, v82, 0x3e0293ee, v24
    v_fmamk_f32 v83, v83, 0x3e0293ee, v24
    v_fmamk_f32 v84, v84, 0x3e0293ee, v24
    v_fmamk_f32 v85, v85, 0x3e0293ee, v24
    v_fmamk_f32 v86, v86, 0x3e0293ee, v24
    v_fmamk_f32 v87, v87, 0x3e0293ee, v24
    v_exp_f32 v80, v80
    v_exp_f32 v81, v81
    v_exp_f32 v82, v82
    v_exp_f32 v83, v83
    v_exp_f32 v84, v84
    v_exp_f32 v85, v85
    v_exp_f32 v86, v86
    v_exp_f32 v87, v87
    v_cvt_pk_bf16_f32 v68, v80, v81
    v_cvt_pk_bf16_f32 v69, v82, v83
    v_cvt_pk_bf16_f32 v70, v84, v85
    v_cvt_pk_bf16_f32 v71, v86, v87
    v_fmamk_f32 v88, v88, 0x3e0293ee, v24
    v_fmamk_f32 v89, v89, 0x3e0293ee, v24
    v_fmamk_f32 v90, v90, 0x3e0293ee, v24
    v_fmamk_f32 v91, v91, 0x3e0293ee, v24
    v_fmamk_f32 v92, v92, 0x3e0293ee, v24
    v_fmamk_f32 v93, v93, 0x3e0293ee, v24
    v_fmamk_f32 v94, v94, 0x3e0293ee, v24
    v_fmamk_f32 v95, v95, 0x3e0293ee, v24
    v_exp_f32 v88, v88
    v_exp_f32 v89, v89
    v_exp_f32 v90, v90
    v_exp_f32 v91, v91
    v_exp_f32 v92, v92
    v_exp_f32 v93, v93
    v_exp_f32 v94, v94
    v_exp_f32 v95, v95
    v_cvt_pk_bf16_f32 v72, v88, v89
    v_cvt_pk_bf16_f32 v73, v90, v91
    v_cvt_pk_bf16_f32 v74, v92, v93
    v_cvt_pk_bf16_f32 v75, v94, v95
    v_fmamk_f32 v136, v136, 0x3e0293ee, v24
    v_fmamk_f32 v137, v137, 0x3e0293ee, v24
    v_fmamk_f32 v138, v138, 0x3e0293ee, v24
    v_fmamk_f32 v139, v139, 0x3e0293ee, v24
    v_fmamk_f32 v140, v140, 0x3e0293ee, v24
    v_fmamk_f32 v141, v141, 0x3e0293ee, v24
    v_fmamk_f32 v142, v142, 0x3e0293ee, v24
    v_fmamk_f32 v143, v143, 0x3e0293ee, v24
    v_exp_f32 v136, v136
    v_exp_f32 v137, v137
    v_exp_f32 v138, v138
    v_exp_f32 v139, v139
    v_exp_f32 v140, v140
    v_exp_f32 v141, v141
    v_exp_f32 v142, v142
    v_exp_f32 v143, v143
    v_cvt_pk_bf16_f32 v136, v136, v137
    v_cvt_pk_bf16_f32 v137, v138, v139
    v_cvt_pk_bf16_f32 v138, v140, v141
    v_cvt_pk_bf16_f32 v139, v142, v143
    v_fmamk_f32 v144, v144, 0x3e0293ee, v24
    v_fmamk_f32 v145, v145, 0x3e0293ee, v24
    v_fmamk_f32 v146, v146, 0x3e0293ee, v24
    v_fmamk_f32 v147, v147, 0x3e0293ee, v24
    v_fmamk_f32 v148, v148, 0x3e0293ee, v24
    v_fmamk_f32 v149, v149, 0x3e0293ee, v24
    v_fmamk_f32 v150, v150, 0x3e0293ee, v24
    v_fmamk_f32 v151, v151, 0x3e0293ee, v24
    v_exp_f32 v144, v144
    v_exp_f32 v145, v145
    v_exp_f32 v146, v146
    v_exp_f32 v147, v147
    v_exp_f32 v148, v148
    v_exp_f32 v149, v149
    v_exp_f32 v150, v150
    v_exp_f32 v151, v151
    v_cvt_pk_bf16_f32 v140, v144, v145
    v_cvt_pk_bf16_f32 v141, v146, v147
    v_cvt_pk_bf16_f32 v142, v148, v149
    v_cvt_pk_bf16_f32 v143, v150, v151
    v_fmamk_f32 v152, v152, 0x3e0293ee, v24
    v_fmamk_f32 v153, v153, 0x3e0293ee, v24
    v_fmamk_f32 v154, v154, 0x3e0293ee, v24
    v_fmamk_f32 v155, v155, 0x3e0293ee, v24
    v_fmamk_f32 v156, v156, 0x3e0293ee, v24
    v_fmamk_f32 v157, v157, 0x3e0293ee, v24
    v_fmamk_f32 v158, v158, 0x3e0293ee, v24
    v_fmamk_f32 v159, v159, 0x3e0293ee, v24
    v_exp_f32 v152, v152
    v_exp_f32 v153, v153
    v_exp_f32 v154, v154
    v_exp_f32 v155, v155
    v_exp_f32 v156, v156
    v_exp_f32 v157, v157
    v_exp_f32 v158, v158
    v_exp_f32 v159, v159
    v_cvt_pk_bf16_f32 v144, v152, v153
    v_cvt_pk_bf16_f32 v145, v154, v155
    v_cvt_pk_bf16_f32 v146, v156, v157
    v_cvt_pk_bf16_f32 v147, v158, v159
    v_fmamk_f32 v160, v160, 0x3e0293ee, v24
    v_fmamk_f32 v161, v161, 0x3e0293ee, v24
    v_fmamk_f32 v162, v162, 0x3e0293ee, v24
    v_fmamk_f32 v163, v163, 0x3e0293ee, v24
    v_fmamk_f32 v164, v164, 0x3e0293ee, v24
    v_fmamk_f32 v165, v165, 0x3e0293ee, v24
    v_fmamk_f32 v166, v166, 0x3e0293ee, v24
    v_fmamk_f32 v167, v167, 0x3e0293ee, v24
    v_exp_f32 v160, v160
    v_exp_f32 v161, v161
    v_exp_f32 v162, v162
    v_exp_f32 v163, v163
    v_exp_f32 v164, v164
    v_exp_f32 v165, v165
    v_exp_f32 v166, v166
    v_exp_f32 v167, v167
    v_cvt_pk_bf16_f32 v148, v160, v161
    v_cvt_pk_bf16_f32 v149, v162, v163
    v_cvt_pk_bf16_f32 v150, v164, v165
    v_cvt_pk_bf16_f32 v151, v166, v167
    v_fmamk_f32 v168, v168, 0x3e0293ee, v24
    v_fmamk_f32 v169, v169, 0x3e0293ee, v24
    v_fmamk_f32 v170, v170, 0x3e0293ee, v24
    v_fmamk_f32 v171, v171, 0x3e0293ee, v24
    v_fmamk_f32 v172, v172, 0x3e0293ee, v24
    v_fmamk_f32 v173, v173, 0x3e0293ee, v24
    v_fmamk_f32 v174, v174, 0x3e0293ee, v24
    v_fmamk_f32 v175, v175, 0x3e0293ee, v24
    v_exp_f32 v168, v168
    v_exp_f32 v169, v169
    v_exp_f32 v170, v170
    v_exp_f32 v171, v171
    v_exp_f32 v172, v172
    v_exp_f32 v173, v173
    v_exp_f32 v174, v174
    v_exp_f32 v175, v175
    v_cvt_pk_bf16_f32 v152, v168, v169
    v_cvt_pk_bf16_f32 v153, v170, v171
    v_cvt_pk_bf16_f32 v154, v172, v173
    v_cvt_pk_bf16_f32 v155, v174, v175
    s_setprio 2
    ds_read_b64_tr_b16 v[32:33], v212 offset:0
    ds_read_b64_tr_b16 v[34:35], v212 offset:4096
    ds_read_b64_tr_b16 v[36:37], v212 offset:8192
    ds_read_b64_tr_b16 v[38:39], v212 offset:12288
    ds_read_b64_tr_b16 v[40:41], v212 offset:16384
    ds_read_b64_tr_b16 v[42:43], v212 offset:20480
    ds_read_b64_tr_b16 v[44:45], v212 offset:24576
    ds_read_b64_tr_b16 v[46:47], v212 offset:28672
    ds_read_b64_tr_b16 v[48:49], v212 offset:32768
    ds_read_b64_tr_b16 v[50:51], v212 offset:36864
    v_add_u32 v212, 0xa000, v212
    ds_read_b64_tr_b16 v[52:53], v212 offset:0
    ds_read_b64_tr_b16 v[54:55], v212 offset:4096
    ds_read_b64_tr_b16 v[224:225], v212 offset:8192
    ds_read_b64_tr_b16 v[226:227], v212 offset:12288
    ds_read_b64_tr_b16 v[228:229], v212 offset:16384
    ds_read_b64_tr_b16 v[230:231], v212 offset:20480
    ds_read_b64_tr_b16 v[232:233], v212 offset:24576
    ds_read_b64_tr_b16 v[234:235], v212 offset:28672
    s_waitcnt lgkmcnt(10)
    v_mfma_f32_16x16x32_bf16 v[176:179], v[32:35], v[56:59], 0
    v_mfma_f32_16x16x32_bf16 v[240:243], v[208:211], v[56:59], 0
    ds_read_b64_tr_b16 v[236:237], v212 offset:32768
    ds_read_b64_tr_b16 v[238:239], v212 offset:36864
    v_mfma_f32_16x16x32_bf16 v[176:179], v[36:39], v[60:63], v[176:179]
    v_mfma_f32_16x16x32_bf16 v[240:243], v[208:211], v[60:63], v[240:243]
    ds_read_b64_tr_b16 v[32:33], v213 offset:0
    ds_read_b64_tr_b16 v[34:35], v213 offset:4096
    v_mfma_f32_16x16x32_bf16 v[176:179], v[40:43], v[64:67], v[176:179]
    v_mfma_f32_16x16x32_bf16 v[240:243], v[208:211], v[64:67], v[240:243]
    ds_read_b64_tr_b16 v[36:37], v213 offset:8192
    ds_read_b64_tr_b16 v[38:39], v213 offset:12288
    v_mfma_f32_16x16x32_bf16 v[176:179], v[44:47], v[68:71], v[176:179]
    v_mfma_f32_16x16x32_bf16 v[240:243], v[208:211], v[68:71], v[240:243]
    ds_read_b64_tr_b16 v[40:41], v213 offset:16384
    ds_read_b64_tr_b16 v[42:43], v213 offset:20480
    s_waitcnt lgkmcnt(10)
    v_mfma_f32_16x16x32_bf16 v[176:179], v[48:51], v[72:75], v[176:179]
    v_mfma_f32_16x16x32_bf16 v[240:243], v[208:211], v[72:75], v[240:243]
    ds_read_b64_tr_b16 v[44:45], v213 offset:24576
    ds_read_b64_tr_b16 v[46:47], v213 offset:28672
    v_mfma_f32_16x16x32_bf16 v[176:179], v[52:55], v[136:139], v[176:179]
    v_mfma_f32_16x16x32_bf16 v[240:243], v[208:211], v[136:139], v[240:243]
    ds_read_b64_tr_b16 v[48:49], v213 offset:32768
    ds_read_b64_tr_b16 v[50:51], v213 offset:36864
    v_mfma_f32_16x16x32_bf16 v[176:179], v[224:227], v[140:143], v[176:179]
    v_mfma_f32_16x16x32_bf16 v[240:243], v[208:211], v[140:143], v[240:243]
    v_add_u32 v213, 0xa000, v213
    ds_read_b64_tr_b16 v[52:53], v213 offset:0
    ds_read_b64_tr_b16 v[54:55], v213 offset:4096
    v_mfma_f32_16x16x32_bf16 v[176:179], v[228:231], v[144:147], v[176:179]
    v_mfma_f32_16x16x32_bf16 v[240:243], v[208:211], v[144:147], v[240:243]
    ds_read_b64_tr_b16 v[224:225], v213 offset:8192
    ds_read_b64_tr_b16 v[226:227], v213 offset:12288
    s_waitcnt lgkmcnt(10)
    v_mfma_f32_16x16x32_bf16 v[176:179], v[232:235], v[148:151], v[176:179]
    v_mfma_f32_16x16x32_bf16 v[240:243], v[208:211], v[148:151], v[240:243]
    ds_read_b64_tr_b16 v[228:229], v213 offset:16384
    ds_read_b64_tr_b16 v[230:231], v213 offset:20480
    v_mfma_f32_16x16x32_bf16 v[176:179], v[236:239], v[152:155], v[176:179]
    v_mfma_f32_16x16x32_bf16 v[240:243], v[208:211], v[152:155], v[240:243]
    ds_read_b64_tr_b16 v[232:233], v213 offset:24576
    ds_read_b64_tr_b16 v[234:235], v213 offset:28672
    v_mfma_f32_16x16x32_bf16 v[180:183], v[32:35], v[56:59], 0
    ds_read_b64_tr_b16 v[236:237], v213 offset:32768
    ds_read_b64_tr_b16 v[238:239], v213 offset:36864
    v_mfma_f32_16x16x32_bf16 v[180:183], v[36:39], v[60:63], v[180:183]
    ds_read_b64_tr_b16 v[32:33], v214 offset:0
    ds_read_b64_tr_b16 v[34:35], v214 offset:4096
    s_waitcnt lgkmcnt(10)
    v_mfma_f32_16x16x32_bf16 v[180:183], v[40:43], v[64:67], v[180:183]
    ds_read_b64_tr_b16 v[36:37], v214 offset:8192
    ds_read_b64_tr_b16 v[38:39], v214 offset:12288
    v_mfma_f32_16x16x32_bf16 v[180:183], v[44:47], v[68:71], v[180:183]
    v_rcp_f32 v25, v240
    s_nop 0
    v_mul_f32 v176, v176, v25
    v_mul_f32 v177, v177, v25
    ds_read_b64_tr_b16 v[40:41], v214 offset:16384
    ds_read_b64_tr_b16 v[42:43], v214 offset:20480
    v_mfma_f32_16x16x32_bf16 v[180:183], v[48:51], v[72:75], v[180:183]
    v_mul_f32 v178, v178, v25
    v_mul_f32 v179, v179, v25
    ds_read_b64_tr_b16 v[44:45], v214 offset:24576
    ds_read_b64_tr_b16 v[46:47], v214 offset:28672
    v_mfma_f32_16x16x32_bf16 v[180:183], v[52:55], v[136:139], v[180:183]
    ds_read_b64_tr_b16 v[48:49], v214 offset:32768
    ds_read_b64_tr_b16 v[50:51], v214 offset:36864
    s_waitcnt lgkmcnt(10)
    v_mfma_f32_16x16x32_bf16 v[180:183], v[224:227], v[140:143], v[180:183]
    v_add_u32 v214, 0xa000, v214
    ds_read_b64_tr_b16 v[52:53], v214 offset:0
    ds_read_b64_tr_b16 v[54:55], v214 offset:4096
    v_mfma_f32_16x16x32_bf16 v[180:183], v[228:231], v[144:147], v[180:183]
    ds_read_b64_tr_b16 v[224:225], v214 offset:8192
    ds_read_b64_tr_b16 v[226:227], v214 offset:12288
    v_mfma_f32_16x16x32_bf16 v[180:183], v[232:235], v[148:151], v[180:183]
    ds_read_b64_tr_b16 v[228:229], v214 offset:16384
    ds_read_b64_tr_b16 v[230:231], v214 offset:20480
    v_mfma_f32_16x16x32_bf16 v[180:183], v[236:239], v[152:155], v[180:183]
    ds_read_b64_tr_b16 v[232:233], v214 offset:24576
    ds_read_b64_tr_b16 v[234:235], v214 offset:28672
    s_waitcnt lgkmcnt(10)
    v_mfma_f32_16x16x32_bf16 v[184:187], v[32:35], v[56:59], 0
    ds_read_b64_tr_b16 v[236:237], v214 offset:32768
    ds_read_b64_tr_b16 v[238:239], v214 offset:36864
    v_mfma_f32_16x16x32_bf16 v[184:187], v[36:39], v[60:63], v[184:187]
    ds_read_b64_tr_b16 v[32:33], v215 offset:0
    ds_read_b64_tr_b16 v[34:35], v215 offset:4096
    v_mfma_f32_16x16x32_bf16 v[184:187], v[40:43], v[64:67], v[184:187]
    ds_read_b64_tr_b16 v[36:37], v215 offset:8192
    ds_read_b64_tr_b16 v[38:39], v215 offset:12288
    v_mfma_f32_16x16x32_bf16 v[184:187], v[44:47], v[68:71], v[184:187]
    v_mul_f32 v180, v180, v25
    v_mul_f32 v181, v181, v25
    v_mul_f32 v182, v182, v25
    v_mul_f32 v183, v183, v25
    ds_read_b64_tr_b16 v[40:41], v215 offset:16384
    ds_read_b64_tr_b16 v[42:43], v215 offset:20480
    s_waitcnt lgkmcnt(10)
    v_mfma_f32_16x16x32_bf16 v[184:187], v[48:51], v[72:75], v[184:187]
    v_cvt_pk_bf16_f32 v176, v176, v177
    v_cvt_pk_bf16_f32 v177, v178, v179
    v_cvt_pk_bf16_f32 v178, v180, v181
    v_cvt_pk_bf16_f32 v179, v182, v183
    ds_read_b64_tr_b16 v[44:45], v215 offset:24576
    ds_read_b64_tr_b16 v[46:47], v215 offset:28672
    v_mfma_f32_16x16x32_bf16 v[184:187], v[52:55], v[136:139], v[184:187]
    v_permlane16_swap_b32 v176, v178
    v_permlane16_swap_b32 v177, v179
    ds_read_b64_tr_b16 v[48:49], v215 offset:32768
    ds_read_b64_tr_b16 v[50:51], v215 offset:36864
    v_mfma_f32_16x16x32_bf16 v[184:187], v[224:227], v[140:143], v[184:187]
    v_add_u32 v215, 0xa000, v215
    ds_read_b64_tr_b16 v[52:53], v215 offset:0
    ds_read_b64_tr_b16 v[54:55], v215 offset:4096
    v_mfma_f32_16x16x32_bf16 v[184:187], v[228:231], v[144:147], v[184:187]
    ds_read_b64_tr_b16 v[224:225], v215 offset:8192
    ds_read_b64_tr_b16 v[226:227], v215 offset:12288
    s_waitcnt lgkmcnt(10)
    v_mfma_f32_16x16x32_bf16 v[184:187], v[232:235], v[148:151], v[184:187]
    ds_read_b64_tr_b16 v[228:229], v215 offset:16384
    ds_read_b64_tr_b16 v[230:231], v215 offset:20480
    v_mfma_f32_16x16x32_bf16 v[184:187], v[236:239], v[152:155], v[184:187]
    ds_read_b64_tr_b16 v[232:233], v215 offset:24576
    ds_read_b64_tr_b16 v[234:235], v215 offset:28672
    v_mfma_f32_16x16x32_bf16 v[188:191], v[32:35], v[56:59], 0
    ds_read_b64_tr_b16 v[236:237], v215 offset:32768
    ds_read_b64_tr_b16 v[238:239], v215 offset:36864
    v_mfma_f32_16x16x32_bf16 v[188:191], v[36:39], v[60:63], v[188:191]
    ds_read_b64_tr_b16 v[32:33], v216 offset:0
    ds_read_b64_tr_b16 v[34:35], v216 offset:4096
    s_waitcnt lgkmcnt(10)
    v_mfma_f32_16x16x32_bf16 v[188:191], v[40:43], v[64:67], v[188:191]
    ds_read_b64_tr_b16 v[36:37], v216 offset:8192
    ds_read_b64_tr_b16 v[38:39], v216 offset:12288
    v_mfma_f32_16x16x32_bf16 v[188:191], v[44:47], v[68:71], v[188:191]
    v_mul_f32 v184, v184, v25
    v_mul_f32 v185, v185, v25
    v_mul_f32 v186, v186, v25
    v_mul_f32 v187, v187, v25
    ds_read_b64_tr_b16 v[40:41], v216 offset:16384
    ds_read_b64_tr_b16 v[42:43], v216 offset:20480
    v_mfma_f32_16x16x32_bf16 v[188:191], v[48:51], v[72:75], v[188:191]
    ds_read_b64_tr_b16 v[44:45], v216 offset:24576
    ds_read_b64_tr_b16 v[46:47], v216 offset:28672
    v_mfma_f32_16x16x32_bf16 v[188:191], v[52:55], v[136:139], v[188:191]
    ds_read_b64_tr_b16 v[48:49], v216 offset:32768
    ds_read_b64_tr_b16 v[50:51], v216 offset:36864
    s_waitcnt lgkmcnt(10)
    v_mfma_f32_16x16x32_bf16 v[188:191], v[224:227], v[140:143], v[188:191]
    v_add_u32 v216, 0xa000, v216
    ds_read_b64_tr_b16 v[52:53], v216 offset:0
    ds_read_b64_tr_b16 v[54:55], v216 offset:4096
    v_mfma_f32_16x16x32_bf16 v[188:191], v[228:231], v[144:147], v[188:191]
    ds_read_b64_tr_b16 v[224:225], v216 offset:8192
    ds_read_b64_tr_b16 v[226:227], v216 offset:12288
    v_mfma_f32_16x16x32_bf16 v[188:191], v[232:235], v[148:151], v[188:191]
    ds_read_b64_tr_b16 v[228:229], v216 offset:16384
    ds_read_b64_tr_b16 v[230:231], v216 offset:20480
    v_mfma_f32_16x16x32_bf16 v[188:191], v[236:239], v[152:155], v[188:191]
    ds_read_b64_tr_b16 v[232:233], v216 offset:24576
    ds_read_b64_tr_b16 v[234:235], v216 offset:28672
    s_waitcnt lgkmcnt(10)
    v_mfma_f32_16x16x32_bf16 v[192:195], v[32:35], v[56:59], 0
    ds_read_b64_tr_b16 v[236:237], v216 offset:32768
    ds_read_b64_tr_b16 v[238:239], v216 offset:36864
    v_mfma_f32_16x16x32_bf16 v[192:195], v[36:39], v[60:63], v[192:195]
    ds_read_b64_tr_b16 v[32:33], v217 offset:0
    ds_read_b64_tr_b16 v[34:35], v217 offset:4096
    v_mfma_f32_16x16x32_bf16 v[192:195], v[40:43], v[64:67], v[192:195]
    ds_read_b64_tr_b16 v[36:37], v217 offset:8192
    ds_read_b64_tr_b16 v[38:39], v217 offset:12288
    v_mfma_f32_16x16x32_bf16 v[192:195], v[44:47], v[68:71], v[192:195]
    v_mul_f32 v188, v188, v25
    v_mul_f32 v189, v189, v25
    v_mul_f32 v190, v190, v25
    v_mul_f32 v191, v191, v25
    ds_read_b64_tr_b16 v[40:41], v217 offset:16384
    ds_read_b64_tr_b16 v[42:43], v217 offset:20480
    s_waitcnt lgkmcnt(10)
    v_mfma_f32_16x16x32_bf16 v[192:195], v[48:51], v[72:75], v[192:195]
    v_cvt_pk_bf16_f32 v184, v184, v185
    v_cvt_pk_bf16_f32 v185, v186, v187
    v_cvt_pk_bf16_f32 v186, v188, v189
    v_cvt_pk_bf16_f32 v187, v190, v191
    ds_read_b64_tr_b16 v[44:45], v217 offset:24576
    ds_read_b64_tr_b16 v[46:47], v217 offset:28672
    v_mfma_f32_16x16x32_bf16 v[192:195], v[52:55], v[136:139], v[192:195]
    v_permlane16_swap_b32 v184, v186
    v_permlane16_swap_b32 v185, v187
    s_nop 0
    v_permlane32_swap_b32 v176, v184
    v_permlane32_swap_b32 v177, v185
    ds_read_b64_tr_b16 v[48:49], v217 offset:32768
    ds_read_b64_tr_b16 v[50:51], v217 offset:36864
    v_mfma_f32_16x16x32_bf16 v[192:195], v[224:227], v[140:143], v[192:195]
    v_permlane32_swap_b32 v178, v186
    v_permlane32_swap_b32 v179, v187
    buffer_store_dwordx4 v[176:179], v220, s[24:27], s30 offen offset:0 sc1 nt
    buffer_store_dwordx4 v[184:187], v220, s[24:27], s30 offen offset:128 sc1 nt
    v_add_u32 v217, 0xa000, v217
    ds_read_b64_tr_b16 v[52:53], v217 offset:0
    ds_read_b64_tr_b16 v[54:55], v217 offset:4096
    v_mfma_f32_16x16x32_bf16 v[192:195], v[228:231], v[144:147], v[192:195]
    ds_read_b64_tr_b16 v[224:225], v217 offset:8192
    ds_read_b64_tr_b16 v[226:227], v217 offset:12288
    s_waitcnt lgkmcnt(10)
    v_mfma_f32_16x16x32_bf16 v[192:195], v[232:235], v[148:151], v[192:195]
    ds_read_b64_tr_b16 v[228:229], v217 offset:16384
    ds_read_b64_tr_b16 v[230:231], v217 offset:20480
    v_mfma_f32_16x16x32_bf16 v[192:195], v[236:239], v[152:155], v[192:195]
    ds_read_b64_tr_b16 v[232:233], v217 offset:24576
    ds_read_b64_tr_b16 v[234:235], v217 offset:28672
    v_mfma_f32_16x16x32_bf16 v[196:199], v[32:35], v[56:59], 0
    ds_read_b64_tr_b16 v[236:237], v217 offset:32768
    ds_read_b64_tr_b16 v[238:239], v217 offset:36864
    v_mfma_f32_16x16x32_bf16 v[196:199], v[36:39], v[60:63], v[196:199]
    ds_read_b64_tr_b16 v[32:33], v218 offset:0
    ds_read_b64_tr_b16 v[34:35], v218 offset:4096
    s_waitcnt lgkmcnt(10)
    v_mfma_f32_16x16x32_bf16 v[196:199], v[40:43], v[64:67], v[196:199]
    ds_read_b64_tr_b16 v[36:37], v218 offset:8192
    ds_read_b64_tr_b16 v[38:39], v218 offset:12288
    v_mfma_f32_16x16x32_bf16 v[196:199], v[44:47], v[68:71], v[196:199]
    v_mul_f32 v192, v192, v25
    v_mul_f32 v193, v193, v25
    v_mul_f32 v194, v194, v25
    v_mul_f32 v195, v195, v25
    ds_read_b64_tr_b16 v[40:41], v218 offset:16384
    ds_read_b64_tr_b16 v[42:43], v218 offset:20480
    v_mfma_f32_16x16x32_bf16 v[196:199], v[48:51], v[72:75], v[196:199]
    ds_read_b64_tr_b16 v[44:45], v218 offset:24576
    ds_read_b64_tr_b16 v[46:47], v218 offset:28672
    v_mfma_f32_16x16x32_bf16 v[196:199], v[52:55], v[136:139], v[196:199]
    ds_read_b64_tr_b16 v[48:49], v218 offset:32768
    ds_read_b64_tr_b16 v[50:51], v218 offset:36864
    s_waitcnt lgkmcnt(10)
    v_mfma_f32_16x16x32_bf16 v[196:199], v[224:227], v[140:143], v[196:199]
    v_add_u32 v218, 0xa000, v218
    ds_read_b64_tr_b16 v[52:53], v218 offset:0
    ds_read_b64_tr_b16 v[54:55], v218 offset:4096
    v_mfma_f32_16x16x32_bf16 v[196:199], v[228:231], v[144:147], v[196:199]
    ds_read_b64_tr_b16 v[224:225], v218 offset:8192
    ds_read_b64_tr_b16 v[226:227], v218 offset:12288
    v_mfma_f32_16x16x32_bf16 v[196:199], v[232:235], v[148:151], v[196:199]
    ds_read_b64_tr_b16 v[228:229], v218 offset:16384
    ds_read_b64_tr_b16 v[230:231], v218 offset:20480
    v_mfma_f32_16x16x32_bf16 v[196:199], v[236:239], v[152:155], v[196:199]
    ds_read_b64_tr_b16 v[232:233], v218 offset:24576
    ds_read_b64_tr_b16 v[234:235], v218 offset:28672
    s_waitcnt lgkmcnt(10)
    v_mfma_f32_16x16x32_bf16 v[200:203], v[32:35], v[56:59], 0
    ds_read_b64_tr_b16 v[236:237], v218 offset:32768
    ds_read_b64_tr_b16 v[238:239], v218 offset:36864
    v_mfma_f32_16x16x32_bf16 v[200:203], v[36:39], v[60:63], v[200:203]
    ds_read_b64_tr_b16 v[32:33], v219 offset:0
    ds_read_b64_tr_b16 v[34:35], v219 offset:4096
    v_mfma_f32_16x16x32_bf16 v[200:203], v[40:43], v[64:67], v[200:203]
    ds_read_b64_tr_b16 v[36:37], v219 offset:8192
    ds_read_b64_tr_b16 v[38:39], v219 offset:12288
    v_mfma_f32_16x16x32_bf16 v[200:203], v[44:47], v[68:71], v[200:203]
    v_mul_f32 v196, v196, v25
    v_mul_f32 v197, v197, v25
    v_mul_f32 v198, v198, v25
    v_mul_f32 v199, v199, v25
    ds_read_b64_tr_b16 v[40:41], v219 offset:16384
    ds_read_b64_tr_b16 v[42:43], v219 offset:20480
    s_waitcnt lgkmcnt(10)
    v_mfma_f32_16x16x32_bf16 v[200:203], v[48:51], v[72:75], v[200:203]
    v_cvt_pk_bf16_f32 v192, v192, v193
    v_cvt_pk_bf16_f32 v193, v194, v195
    v_cvt_pk_bf16_f32 v194, v196, v197
    v_cvt_pk_bf16_f32 v195, v198, v199
    ds_read_b64_tr_b16 v[44:45], v219 offset:24576
    ds_read_b64_tr_b16 v[46:47], v219 offset:28672
    v_mfma_f32_16x16x32_bf16 v[200:203], v[52:55], v[136:139], v[200:203]
    v_permlane16_swap_b32 v192, v194
    v_permlane16_swap_b32 v193, v195
    ds_read_b64_tr_b16 v[48:49], v219 offset:32768
    ds_read_b64_tr_b16 v[50:51], v219 offset:36864
    v_mfma_f32_16x16x32_bf16 v[200:203], v[224:227], v[140:143], v[200:203]
    v_add_u32 v219, 0xa000, v219
    ds_read_b64_tr_b16 v[52:53], v219 offset:0
    ds_read_b64_tr_b16 v[54:55], v219 offset:4096
    v_mfma_f32_16x16x32_bf16 v[200:203], v[228:231], v[144:147], v[200:203]
    ds_read_b64_tr_b16 v[224:225], v219 offset:8192
    ds_read_b64_tr_b16 v[226:227], v219 offset:12288
    s_waitcnt lgkmcnt(10)
    v_mfma_f32_16x16x32_bf16 v[200:203], v[232:235], v[148:151], v[200:203]
    ds_read_b64_tr_b16 v[228:229], v219 offset:16384
    ds_read_b64_tr_b16 v[230:231], v219 offset:20480
    v_mfma_f32_16x16x32_bf16 v[200:203], v[236:239], v[152:155], v[200:203]
    ds_read_b64_tr_b16 v[232:233], v219 offset:24576
    ds_read_b64_tr_b16 v[234:235], v219 offset:28672
    v_mfma_f32_16x16x32_bf16 v[204:207], v[32:35], v[56:59], 0
    ds_read_b64_tr_b16 v[236:237], v219 offset:32768
    ds_read_b64_tr_b16 v[238:239], v219 offset:36864
    v_mfma_f32_16x16x32_bf16 v[204:207], v[36:39], v[60:63], v[204:207]
    s_waitcnt lgkmcnt(8)
    v_mfma_f32_16x16x32_bf16 v[204:207], v[40:43], v[64:67], v[204:207]
    v_mfma_f32_16x16x32_bf16 v[204:207], v[44:47], v[68:71], v[204:207]
    v_mfma_f32_16x16x32_bf16 v[204:207], v[48:51], v[72:75], v[204:207]
    v_mfma_f32_16x16x32_bf16 v[204:207], v[52:55], v[136:139], v[204:207]
    v_mul_f32 v200, v200, v25
    v_mul_f32 v201, v201, v25
    v_mul_f32 v202, v202, v25
    v_mul_f32 v203, v203, v25
    s_waitcnt lgkmcnt(0)
    v_mfma_f32_16x16x32_bf16 v[204:207], v[224:227], v[140:143], v[204:207]
    v_mfma_f32_16x16x32_bf16 v[204:207], v[228:231], v[144:147], v[204:207]
    v_mfma_f32_16x16x32_bf16 v[204:207], v[232:235], v[148:151], v[204:207]
    v_mfma_f32_16x16x32_bf16 v[204:207], v[236:239], v[152:155], v[204:207]
    s_nop 7
    v_mul_f32 v204, v204, v25
    v_mul_f32 v205, v205, v25
    v_mul_f32 v206, v206, v25
    v_mul_f32 v207, v207, v25
    v_cvt_pk_bf16_f32 v200, v200, v201
    v_cvt_pk_bf16_f32 v201, v202, v203
    v_cvt_pk_bf16_f32 v202, v204, v205
    v_cvt_pk_bf16_f32 v203, v206, v207
    s_nop 0
    v_permlane16_swap_b32 v200, v202
    v_permlane16_swap_b32 v201, v203
    s_nop 0
    v_permlane32_swap_b32 v192, v200
    v_permlane32_swap_b32 v193, v201
    v_permlane32_swap_b32 v194, v202
    v_permlane32_swap_b32 v195, v203
    buffer_store_dwordx4 v[192:195], v220, s[24:27], s30 offen offset:64 sc1 nt
    buffer_store_dwordx4 v[200:203], v220, s[24:27], s30 offen offset:192 sc1 nt
L_fin:
L_end:
    s_endpgm
.section .rodata,"a"
.p2align 6
.amdhsa_kernel standalone__gqa_softmax__near_ridge_kernel
  .amdhsa_next_free_vgpr 256
  .amdhsa_next_free_sgpr 100
  .amdhsa_accum_offset 256
  .amdhsa_group_segment_fixed_size 0
  .amdhsa_kernarg_size 48
  .amdhsa_user_sgpr_count 2
  .amdhsa_user_sgpr_kernarg_segment_ptr 1
  .amdhsa_system_sgpr_workgroup_id_x 1
.end_amdhsa_kernel
```
